```python
import torch

def _softmax(x, axis=-1):
    return torch.softmax(x, dim=axis)
def _gelu(x):
    return torch.nn.functional.gelu(x, approximate="tanh")
def _silu(x):
    return torch.nn.functional.silu(x)
def _sigmoid(x):
    return torch.sigmoid(x)
def _layernorm(x, axis=-1, eps=1e-5):
    m = x.mean(dim=axis, keepdim=True)
    v = x.var(dim=axis, keepdim=True, unbiased=False)
    return (x - m) / torch.sqrt(v + eps)
def _scatter_add(tgt, idx, src, axis=0):
    return tgt.clone().index_add_(axis, idx, src)
def _segment_sum(src, seg, n):
    out = torch.zeros((n,) + src.shape[1:], dtype=src.dtype)
    return out.index_add_(0, seg, src)
def _pad(x, pw):
    flat = tuple(v for pair in reversed(pw) for v in pair)
    return torch.nn.functional.pad(x, flat)

kernel_name = 'standalone__weight_only_int_quip__prompt'

def setup_inputs():

    _w = (lambda a: (lambda t: t.to(torch.bfloat16) if t.is_floating_point() else t)(torch.as_tensor(a)))
    B, S, D, F = 1, 2048, 1024, 3584
    G = 32 if 32 > 0 else D
    D = (D // G) * G
    ng = D // G
    bits = 8 if 8 > 0 else 4
    qmax = 1 << bits
    qw = torch.randint(0, qmax, (D, F)).to(torch.int32)
    U, _ = (lambda *_a, **_k: torch.linalg.qr(*[torch.as_tensor(_x).float() for _x in _a], **_k))((lambda *s: torch.randn(*s, dtype=torch.bfloat16) * 0.05)(D, D))
    V, _ = (lambda *_a, **_k: torch.linalg.qr(*[torch.as_tensor(_x).float() for _x in _a], **_k))((lambda *s: torch.randn(*s, dtype=torch.bfloat16) * 0.05)(F, F))
    return {
        "x": _w((lambda *s: torch.randn(*s, dtype=torch.bfloat16) * 0.05)(B, S, D)),
        "qw": _w(qw),
        "scales": _w(torch.abs((lambda *s: torch.randn(*s, dtype=torch.bfloat16) * 0.05)(ng, F)) * 0.02 + 0.005),
        "zeros": _w(torch.full((ng, F), qmax / 2.0, dtype=float)),
        "U": _w(U.to(float)),
        "V": _w(V.to(float)),
    }

def reference(x, qw, scales, zeros, U, V):
    B, S, D = x.shape
    ng, F = scales.shape
    G = D // ng
    s = (lambda x, n, axis: torch.repeat_interleave(x, n, dim=axis))(scales, G, axis=0)
    z = (lambda x, n, axis: torch.repeat_interleave(x, n, dim=axis))(zeros, G, axis=0)
    wq = ((lambda x, dt: x.to(dt))(qw, x.dtype) - z) * s
    xr = torch.einsum("bsd,de->bse", x, U)
    h  = torch.einsum("bse,ef->bsf", xr, wq)
    y  = torch.einsum("bsf,fg->bsg", h, V)
    return y
```

```asm
; @launch grid=(256,1,1) block=(512,1,1) lds=163840
.amdgcn_target "amdgcn-amd-amdhsa--gfx950"
.text
.globl standalone__weight_only_int_quip__prompt_kernel
.p2align 8
.type standalone__weight_only_int_quip__prompt_kernel,@function
standalone__weight_only_int_quip__prompt_kernel:
s_cmp_ge_u32 s2, 256
s_cbranch_scc1 L_end
s_load_dwordx16 s[48:63], s[0:1], 0
s_load_dwordx2 s[64:65], s[0:1], 64
s_memrealtime s[68:69]
v_lshrrev_b32 v1, 6, v0
s_and_b32 s42, s2, 7
v_readfirstlane_b32 s16, v1
s_lshr_b32 s43, s2, 3
s_mov_b32 s100, 0
s_or_b32 s19, s2, s16
s_cmp_lg_u32 s19, 0
s_cbranch_scc1 L_non
s_waitcnt lgkmcnt(0)
s_mov_b32 s28, s62
s_mov_b32 s29, s63
s_mov_b32 s30, 256
s_mov_b32 s31, 0x20000
s_or_b32 s19, s68, 1
v_mov_b32 v2, 0
v_mov_b32 v4, s19
v_mov_b32 v5, s69
s_mov_b64 exec, 1
buffer_store_dwordx2 v[4:5], v2, s[28:31], 0 offen sc1
s_mov_b64 exec, -1
L_non:
s_cmp_ge_u32 s2, 32
s_cbranch_scc1 L_g
s_and_b32 s36, s16, 3
s_getpc_b64 s[38:39]
cp_1:
s_sub_u32 s38, s38, cp_1-standalone__weight_only_int_quip__prompt_kernel
s_subb_u32 s39, s39, 0
s_lshl_b32 s19, s36, 13
v_mbcnt_lo_u32_b32 v250, -1, 0
v_mbcnt_hi_u32_b32 v250, -1, v250
v_lshl_add_u32 v250, v250, 7, s19
v_min_u32 v250, L_end-standalone__weight_only_int_quip__prompt_kernel, v250
global_load_dword v251, v250, s[38:39]
s_branch L_xr
L_g:
s_sub_u32 s43, s43, 4
s_and_b32 s44, s43, 3
s_lshr_b32 s45, s43, 2
s_add_u32 s22, s44, s45
s_and_b32 s22, s22, 3
s_and_b32 s46, s42, 1
s_lshl_b32 s46, s46, 2
s_add_u32 s44, s44, s46
s_lshr_b32 s46, s42, 1
s_mul_i32 s46, s46, 7
s_add_u32 s45, s45, s46
s_mov_b32 s23, 0
s_and_b32 s94, s42, 1
s_mul_i32 s94, s94, 4
v_and_b32 v40, 63, v0
v_lshrrev_b32 v42, 4, v40
v_bfe_u32 v41, v40, 3, 1
v_lshl_add_u32 v41, v42, 2, v41
v_sub_u32 v42, 0, v42
v_and_b32 v42, 3, v42
v_xor_b32 v42, v42, v40
v_and_b32 v42, 7, v42
v_mul_u32_u24 v43, 14336, v41
v_lshl_add_u32 v43, v42, 4, v43
v_add_u32 v46, 28672, v43
v_lshlrev_b32 v44, 3, v42
v_bfe_u32 v45, v40, 2, 1
v_lshlrev_b32 v45, 10, v45
v_lshl_add_u32 v45, v41, 6, v45
v_and_b32 v48, 3, v40
v_lshl_add_u32 v45, v48, 4, v45
s_and_b32 s36, s16, 3
s_lshl_b32 s37, s44, 2
s_add_u32 s36, s36, s37
s_add_u32 s37, s23, s45
s_lshr_b32 s39, s16, 2
s_mul_i32 s38, s36, 458752
s_lshl_b32 s19, s37, 8
s_add_u32 s38, s38, s19
s_mul_i32 s19, s39, 229376
s_add_u32 s38, s38, s19
s_mul_i32 s40, s36, 7168
s_lshl_b32 s19, s37, 7
s_add_u32 s40, s40, s19
s_mul_i32 s41, s44, 56
s_add_u32 s41, s41, s37
s_lshl_b32 s41, s41, 14
s_and_b32 s19, s36, 3
s_lshl_b32 s19, s19, 12
s_add_u32 s41, s41, s19
s_lshl_b32 s19, s39, 11
s_add_u32 s41, s41, s19
s_waitcnt lgkmcnt(0)
s_mov_b32 s12, s50
s_mov_b32 s13, s51
s_mov_b32 s14, 14680064
s_mov_b32 s15, 0x20000
buffer_load_dwordx4 v[84:87], v43, s[12:15], s38 offen
buffer_load_dwordx4 v[88:91], v43, s[12:15], s38 offen offset:128
buffer_load_dwordx4 v[92:95], v46, s[12:15], s38 offen
buffer_load_dwordx4 v[96:99], v46, s[12:15], s38 offen offset:128
s_mov_b32 s24, s52
s_mov_b32 s25, s53
s_mov_b32 s26, 229376
s_mov_b32 s27, 0x20000
s_mov_b32 s28, s54
s_mov_b32 s29, s55
s_mov_b32 s30, 229376
s_mov_b32 s31, 0x20000
buffer_load_dwordx2 v[116:117], v44, s[24:27], s40 offen offset:0
buffer_load_dwordx2 v[120:121], v44, s[28:31], s40 offen offset:0
buffer_load_dwordx2 v[118:119], v44, s[24:27], s40 offen offset:64
buffer_load_dwordx2 v[122:123], v44, s[28:31], s40 offen offset:64
s_mov_b32 s28, s62
s_mov_b32 s29, s63
s_mov_b32 s30, 256
s_mov_b32 s31, 0x20000
v_mov_b32 v132, 0
buffer_load_dwordx2 v[134:135], v132, s[28:31], 0 offen sc1
s_mov_b32 s4, s64
s_mov_b32 s5, s65
s_mov_b32 s6, 7340032
s_mov_b32 s7, 0x20000
s_mul_i32 s20, s44, 917504
s_lshl_b32 s21, s45, 8
s_mov_b32 s47, s41
s_mov_b32 s3, 0
s_mov_b32 s8, s58
s_mov_b32 s9, s59
s_mov_b32 s10, 25690112
s_mov_b32 s11, 0x20000
s_and_b32 s17, s16, 3
v_and_b32 v1, 63, v0
s_mul_i32 s19, s17, 4096
s_add_u32 s19, s19, s20
v_lshl_add_u32 v8, v1, 4, s19
v_add_u32 v9, 1024, v8
v_add_u32 v10, 2048, v8
v_add_u32 v11, 3072, v8
s_mul_i32 s19, s17, 16
s_add_u32 s19, s19, 0
v_lshrrev_b32 v2, 4, v1
v_add_u32 v2, s19, v2
v_and_b32 v3, 15, v1
v_and_b32 v4, 7, v2
v_lshlrev_b32 v4, 1, v4
v_xor_b32 v3, v3, v4
v_mul_u32_u24 v2, 7168, v2
v_lshrrev_b32 v4, 3, v3
v_mul_lo_u32 v4, v4, s3
v_add_u32 v2, v2, v4
v_lshl_add_u32 v2, v3, 4, v2
v_add_u32 v12, s21, v2
s_mul_i32 s19, s17, 16
s_add_u32 s19, s19, 4
v_lshrrev_b32 v2, 4, v1
v_add_u32 v2, s19, v2
v_and_b32 v3, 15, v1
v_and_b32 v4, 7, v2
v_lshlrev_b32 v4, 1, v4
v_xor_b32 v3, v3, v4
v_mul_u32_u24 v2, 7168, v2
v_lshrrev_b32 v4, 3, v3
v_mul_lo_u32 v4, v4, s3
v_add_u32 v2, v2, v4
v_lshl_add_u32 v2, v3, 4, v2
v_add_u32 v13, s21, v2
s_mul_i32 s19, s17, 16
s_add_u32 s19, s19, 8
v_lshrrev_b32 v2, 4, v1
v_add_u32 v2, s19, v2
v_and_b32 v3, 15, v1
v_and_b32 v4, 7, v2
v_lshlrev_b32 v4, 1, v4
v_xor_b32 v3, v3, v4
v_mul_u32_u24 v2, 7168, v2
v_lshrrev_b32 v4, 3, v3
v_mul_lo_u32 v4, v4, s3
v_add_u32 v2, v2, v4
v_lshl_add_u32 v2, v3, 4, v2
v_add_u32 v14, s21, v2
s_mul_i32 s19, s17, 16
s_add_u32 s19, s19, 12
v_lshrrev_b32 v2, 4, v1
v_add_u32 v2, s19, v2
v_and_b32 v3, 15, v1
v_and_b32 v4, 7, v2
v_lshlrev_b32 v4, 1, v4
v_xor_b32 v3, v3, v4
v_mul_u32_u24 v2, 7168, v2
v_lshrrev_b32 v4, 3, v3
v_mul_lo_u32 v4, v4, s3
v_add_u32 v2, v2, v4
v_lshl_add_u32 v2, v3, 4, v2
v_add_u32 v15, s21, v2
s_mul_i32 s32, s17, 4096
s_mul_i32 s33, s17, 4096
s_add_u32 s33, s33, 65536
s_mov_b32 s34, 0
s_mov_b32 s35, 0
s_waitcnt vmcnt(7)
v_cvt_f32_i32 v84, v84
v_cvt_f32_i32 v85, v85
v_cvt_f32_i32 v86, v86
v_cvt_f32_i32 v87, v87
v_cvt_f32_i32 v88, v88
v_cvt_f32_i32 v89, v89
v_cvt_f32_i32 v90, v90
v_cvt_f32_i32 v91, v91
v_cvt_pk_bf16_f32 v48, v84, v85
v_cvt_pk_bf16_f32 v49, v86, v87
v_cvt_pk_bf16_f32 v50, v88, v89
v_cvt_pk_bf16_f32 v51, v90, v91
v_lshlrev_b32 v84, 16, v48
v_and_b32 v85, 0xffff0000, v48
v_lshlrev_b32 v86, 16, v49
v_and_b32 v87, 0xffff0000, v49
v_lshlrev_b32 v88, 16, v50
v_and_b32 v89, 0xffff0000, v50
v_lshlrev_b32 v90, 16, v51
v_and_b32 v91, 0xffff0000, v51
s_waitcnt vmcnt(5)
v_cvt_f32_i32 v92, v92
v_cvt_f32_i32 v93, v93
v_cvt_f32_i32 v94, v94
v_cvt_f32_i32 v95, v95
v_cvt_f32_i32 v96, v96
v_cvt_f32_i32 v97, v97
v_cvt_f32_i32 v98, v98
v_cvt_f32_i32 v99, v99
v_cvt_pk_bf16_f32 v48, v92, v93
v_cvt_pk_bf16_f32 v49, v94, v95
v_cvt_pk_bf16_f32 v50, v96, v97
v_cvt_pk_bf16_f32 v51, v98, v99
v_lshlrev_b32 v92, 16, v48
v_and_b32 v93, 0xffff0000, v48
v_lshlrev_b32 v94, 16, v49
v_and_b32 v95, 0xffff0000, v49
v_lshlrev_b32 v96, 16, v50
v_and_b32 v97, 0xffff0000, v50
v_lshlrev_b32 v98, 16, v51
v_and_b32 v99, 0xffff0000, v51
s_waitcnt vmcnt(1)
v_lshlrev_b32 v52, 16, v116
v_and_b32 v53, 0xffff0000, v116
v_lshlrev_b32 v60, 16, v120
v_and_b32 v61, 0xffff0000, v120
v_lshlrev_b32 v54, 16, v117
v_and_b32 v55, 0xffff0000, v117
v_lshlrev_b32 v62, 16, v121
v_and_b32 v63, 0xffff0000, v121
v_lshlrev_b32 v56, 16, v118
v_and_b32 v57, 0xffff0000, v118
v_lshlrev_b32 v64, 16, v122
v_and_b32 v65, 0xffff0000, v122
v_lshlrev_b32 v58, 16, v119
v_and_b32 v59, 0xffff0000, v119
v_lshlrev_b32 v66, 16, v123
v_and_b32 v67, 0xffff0000, v123
v_pk_add_f32 v[84:85], v[84:85], v[60:61] neg_lo:[0,1] neg_hi:[0,1]
v_pk_add_f32 v[86:87], v[86:87], v[62:63] neg_lo:[0,1] neg_hi:[0,1]
v_pk_add_f32 v[88:89], v[88:89], v[64:65] neg_lo:[0,1] neg_hi:[0,1]
v_pk_add_f32 v[90:91], v[90:91], v[66:67] neg_lo:[0,1] neg_hi:[0,1]
v_cvt_pk_bf16_f32 v48, v84, v85
v_cvt_pk_bf16_f32 v49, v86, v87
v_cvt_pk_bf16_f32 v50, v88, v89
v_cvt_pk_bf16_f32 v51, v90, v91
v_lshlrev_b32 v84, 16, v48
v_and_b32 v85, 0xffff0000, v48
v_lshlrev_b32 v86, 16, v49
v_and_b32 v87, 0xffff0000, v49
v_lshlrev_b32 v88, 16, v50
v_and_b32 v89, 0xffff0000, v50
v_lshlrev_b32 v90, 16, v51
v_and_b32 v91, 0xffff0000, v51
v_pk_mul_f32 v[84:85], v[84:85], v[52:53]
v_pk_mul_f32 v[86:87], v[86:87], v[54:55]
v_pk_mul_f32 v[88:89], v[88:89], v[56:57]
v_pk_mul_f32 v[90:91], v[90:91], v[58:59]
v_cvt_pk_bf16_f32 v68, v84, v85
v_cvt_pk_bf16_f32 v69, v86, v87
v_cvt_pk_bf16_f32 v70, v88, v89
v_cvt_pk_bf16_f32 v71, v90, v91
buffer_store_dwordx4 v[68:71], v45, s[4:7], s41 offen offset:0 sc1
v_pk_add_f32 v[92:93], v[92:93], v[60:61] neg_lo:[0,1] neg_hi:[0,1]
v_pk_add_f32 v[94:95], v[94:95], v[62:63] neg_lo:[0,1] neg_hi:[0,1]
v_pk_add_f32 v[96:97], v[96:97], v[64:65] neg_lo:[0,1] neg_hi:[0,1]
v_pk_add_f32 v[98:99], v[98:99], v[66:67] neg_lo:[0,1] neg_hi:[0,1]
v_cvt_pk_bf16_f32 v48, v92, v93
v_cvt_pk_bf16_f32 v49, v94, v95
v_cvt_pk_bf16_f32 v50, v96, v97
v_cvt_pk_bf16_f32 v51, v98, v99
v_lshlrev_b32 v92, 16, v48
v_and_b32 v93, 0xffff0000, v48
v_lshlrev_b32 v94, 16, v49
v_and_b32 v95, 0xffff0000, v49
v_lshlrev_b32 v96, 16, v50
v_and_b32 v97, 0xffff0000, v50
v_lshlrev_b32 v98, 16, v51
v_and_b32 v99, 0xffff0000, v51
v_pk_mul_f32 v[92:93], v[92:93], v[52:53]
v_pk_mul_f32 v[94:95], v[94:95], v[54:55]
v_pk_mul_f32 v[96:97], v[96:97], v[56:57]
v_pk_mul_f32 v[98:99], v[98:99], v[58:59]
v_cvt_pk_bf16_f32 v72, v92, v93
v_cvt_pk_bf16_f32 v73, v94, v95
v_cvt_pk_bf16_f32 v74, v96, v97
v_cvt_pk_bf16_f32 v75, v98, v99
buffer_store_dwordx4 v[72:75], v45, s[4:7], s41 offen offset:128 sc1
s_waitcnt vmcnt(2)
s_mov_b32 s19, 32768
v_readfirstlane_b32 s66, v134
v_readfirstlane_b32 s67, v135
s_nop 3
s_cmp_lg_u32 s66, 0
s_cbranch_scc1 nd_3
nn_2:
buffer_load_dwordx2 v[134:135], v132, s[28:31], 0 offen sc1
s_waitcnt vmcnt(0)
v_readfirstlane_b32 s66, v134
v_readfirstlane_b32 s67, v135
s_nop 3
s_cmp_lg_u32 s66, 0
s_cbranch_scc1 nd_3
s_sleep 4
s_sub_u32 s19, s19, 1
s_cmp_lg_u32 s19, 0
s_cbranch_scc1 nn_2
nd_3:
s_add_u32 s24, s64, 25165824
s_addc_u32 s25, s65, 0
s_mov_b32 s26, 32768
s_mov_b32 s27, 0x20000
s_lshl_b32 s28, s44, 8
s_lshl_b32 s41, s45, 3
s_add_u32 s46, s28, s41
s_waitcnt vmcnt(0)
s_barrier
s_cmp_lg_u32 s16, 0
s_cbranch_scc1 f0_4
v_mov_b32 v48, 0
v_mov_b32 v50, s66
v_mov_b32 v51, s67
s_mov_b64 exec, 1
buffer_store_dwordx2 v[50:51], v48, s[24:27], s46 offen sc1
s_mov_b64 exec, -1
f0_4:
s_barrier
s_mul_i32 s20, s44, 917504
s_lshl_b32 s21, s45, 8
s_mov_b32 s8, s58
s_mov_b32 s9, s59
s_mov_b32 s10, 25690112
s_mov_b32 s11, 0x20000
s_add_u32 s12, s64, 8388608
s_addc_u32 s13, s65, 0
s_mov_b32 s14, 7340032
s_mov_b32 s15, 0x20000
s_cmp_ge_u32 s16, 4
s_cbranch_scc1 L_gc
s_mov_b32 s34, 0
s_mov_b32 s35, 0
p1_pre_5:
s_add_u32 s37, s22, 52
s_cmp_gt_u32 s34, s37
s_cselect_b32 s37, 0, 1
s_sub_u32 s37, s34, s37
s_and_b32 s36, s37, 3
s_cmp_eq_u32 s36, s22
s_cselect_b32 s36, 4, 0
s_add_u32 s36, s36, s37
s_cmp_eq_u32 s34, 0
s_cselect_b32 s36, s22, s36
s_add_u32 s36, s36, s23
s_sub_u32 s37, s36, 56
s_cmp_ge_u32 s36, 56
s_cselect_b32 s36, s37, s36
s_xor_b32 s36, s36, s94
s_mul_i32 s39, s36, 458752
s_mul_i32 s41, s35, 16384
s_add_u32 s41, s41, s33
s_add_u32 m0, s41, 0
s_nop 0
buffer_load_dwordx4 v12, s[8:11], s39 offen  lds
s_add_u32 m0, s41, 1024
s_nop 0
buffer_load_dwordx4 v13, s[8:11], s39 offen  lds
s_add_u32 m0, s41, 2048
s_nop 0
buffer_load_dwordx4 v14, s[8:11], s39 offen  lds
s_add_u32 m0, s41, 3072
s_nop 0
buffer_load_dwordx4 v15, s[8:11], s39 offen  lds
s_add_u32 s34, s34, 1
s_add_u32 s35, s35, 1
s_cmp_eq_u32 s35, 4
s_cselect_b32 s35, 0, s35
s_cmp_lt_u32 s34, 2
s_cbranch_scc1 p1_pre_5
s_add_u32 s29, s28, 2048
s_add_u32 s30, s46, 2048
s_lshl_b32 s36, s44, 2
s_add_u32 s36, s36, s16
s_sub_u32 s37, 28, s23
s_add_u32 s37, s37, s45
s_mul_i32 s90, s36, 458752
s_lshl_b32 s19, s37, 8
s_add_u32 s90, s90, s19
s_add_u32 s91, s90, 229376
s_mul_i32 s92, s36, 7168
s_lshl_b32 s19, s37, 7
s_add_u32 s92, s92, s19
s_mul_i32 s93, s44, 56
s_add_u32 s93, s93, s37
s_lshl_b32 s93, s93, 14
s_and_b32 s19, s36, 3
s_lshl_b32 s19, s19, 12
s_add_u32 s93, s93, s19
s_lshl_b32 s95, s45, 6
s_lshl_b32 s19, s44, 3
s_add_u32 s95, s95, s19
s_add_u32 s95, s95, 4096
s_cmp_lg_u32 s16, 0
s_cbranch_scc1 p1w_6
v_min_u32 v24, 27, v1
v_lshlrev_b32 v24, 3, v24
s_mov_b32 s19, 32768
pl_7:
buffer_load_dwordx2 v[26:27], v24, s[24:27], s28 offen sc1
s_waitcnt vmcnt(0)
v_cmp_ne_u64 vcc, s[66:67], v[26:27]
s_nop 4
s_cmp_eq_u64 vcc, 0
s_cbranch_scc1 pd_8
s_add_u32 s100, s100, 1
s_sleep 2
s_sub_u32 s19, s19, 1
s_cmp_lg_u32 s19, 0
s_cbranch_scc1 pl_7
pd_8:
p1w_6:
s_barrier
s_waitcnt vmcnt(0)
s_mov_b32 s34, 0
s_mov_b32 s35, 0
p1_pre_9:
s_add_u32 s37, s22, 52
s_cmp_gt_u32 s34, s37
s_cselect_b32 s37, 0, 1
s_sub_u32 s37, s34, s37
s_and_b32 s36, s37, 3
s_cmp_eq_u32 s36, s22
s_cselect_b32 s36, 4, 0
s_add_u32 s36, s36, s37
s_cmp_eq_u32 s34, 0
s_cselect_b32 s36, s22, s36
s_add_u32 s36, s36, s23
s_sub_u32 s37, s36, 56
s_cmp_ge_u32 s36, 56
s_cselect_b32 s36, s37, s36
s_xor_b32 s36, s36, s94
s_mul_i32 s38, s36, 16384
s_mul_i32 s40, s35, 16384
s_add_u32 s40, s40, s32
s_add_u32 m0, s40, 0
s_nop 0
buffer_load_dwordx4 v8, s[4:7], s38 offen sc1 lds
s_add_u32 m0, s40, 1024
s_nop 0
buffer_load_dwordx4 v9, s[4:7], s38 offen sc1 lds
s_add_u32 m0, s40, 2048
s_nop 0
buffer_load_dwordx4 v10, s[4:7], s38 offen sc1 lds
s_add_u32 m0, s40, 3072
s_nop 0
buffer_load_dwordx4 v11, s[4:7], s38 offen sc1 lds
s_add_u32 s34, s34, 1
s_add_u32 s35, s35, 1
s_cmp_eq_u32 s35, 4
s_cselect_b32 s35, 0, s35
s_cmp_lt_u32 s34, 2
s_cbranch_scc1 p1_pre_9
s_waitcnt vmcnt(4)
s_barrier
s_add_u32 s37, s22, 52
s_cmp_gt_u32 s34, s37
s_cselect_b32 s37, 0, 1
s_sub_u32 s37, s34, s37
s_and_b32 s36, s37, 3
s_cmp_eq_u32 s36, s22
s_cselect_b32 s36, 4, 0
s_add_u32 s36, s36, s37
s_cmp_eq_u32 s34, 0
s_cselect_b32 s36, s22, s36
s_add_u32 s36, s36, s23
s_sub_u32 s37, s36, 56
s_cmp_ge_u32 s36, 56
s_cselect_b32 s36, s37, s36
s_xor_b32 s36, s36, s94
s_mul_i32 s39, s36, 458752
s_mul_i32 s41, s35, 16384
s_add_u32 s41, s41, s33
s_mul_i32 s38, s36, 16384
s_mul_i32 s40, s35, 16384
s_add_u32 s40, s40, s32
s_add_u32 m0, s41, 0
s_nop 0
buffer_load_dwordx4 v12, s[8:11], s39 offen  lds
s_add_u32 m0, s41, 1024
s_nop 0
buffer_load_dwordx4 v13, s[8:11], s39 offen  lds
s_add_u32 m0, s41, 2048
s_nop 0
buffer_load_dwordx4 v14, s[8:11], s39 offen  lds
s_add_u32 m0, s41, 3072
s_nop 0
buffer_load_dwordx4 v15, s[8:11], s39 offen  lds
s_add_u32 m0, s40, 0
s_nop 0
buffer_load_dwordx4 v8, s[4:7], s38 offen sc1 lds
s_add_u32 m0, s40, 1024
s_nop 0
buffer_load_dwordx4 v9, s[4:7], s38 offen sc1 lds
s_add_u32 m0, s40, 2048
s_nop 0
buffer_load_dwordx4 v10, s[4:7], s38 offen sc1 lds
s_add_u32 m0, s40, 3072
s_nop 0
buffer_load_dwordx4 v11, s[4:7], s38 offen sc1 lds
s_add_u32 s34, s34, 1
s_add_u32 s35, s35, 1
s_cmp_eq_u32 s35, 4
s_cselect_b32 s35, 0, s35
s_waitcnt vmcnt(8)
s_barrier
s_mov_b32 s12, s52
s_mov_b32 s13, s53
s_mov_b32 s14, 229376
s_mov_b32 s15, 0x20000
s_mov_b32 s96, s54
s_mov_b32 s97, s55
s_mov_b32 s98, 229376
s_mov_b32 s99, 0x20000
buffer_load_dwordx2 v[116:117], v44, s[12:15], s92 offen offset:0
buffer_load_dwordx2 v[120:121], v44, s[96:99], s92 offen offset:0
buffer_load_dwordx2 v[118:119], v44, s[12:15], s92 offen offset:64
buffer_load_dwordx2 v[122:123], v44, s[96:99], s92 offen offset:64
s_mov_b32 s12, s50
s_mov_b32 s13, s51
s_mov_b32 s14, 14680064
s_mov_b32 s15, 0x20000
buffer_load_dwordx4 v[84:87], v43, s[12:15], s90 offen
buffer_load_dwordx4 v[88:91], v43, s[12:15], s90 offen offset:128
buffer_load_dwordx4 v[92:95], v46, s[12:15], s90 offen
buffer_load_dwordx4 v[96:99], v46, s[12:15], s90 offen offset:128
buffer_load_dwordx4 v[100:103], v43, s[12:15], s91 offen
buffer_load_dwordx4 v[104:107], v43, s[12:15], s91 offen offset:128
buffer_load_dwordx4 v[108:111], v46, s[12:15], s91 offen
buffer_load_dwordx4 v[112:115], v46, s[12:15], s91 offen offset:128
s_add_u32 s37, s22, 52
s_cmp_gt_u32 s34, s37
s_cselect_b32 s37, 0, 1
s_sub_u32 s37, s34, s37
s_and_b32 s36, s37, 3
s_cmp_eq_u32 s36, s22
s_cselect_b32 s36, 4, 0
s_add_u32 s36, s36, s37
s_cmp_eq_u32 s34, 0
s_cselect_b32 s36, s22, s36
s_add_u32 s36, s36, s23
s_sub_u32 s37, s36, 56
s_cmp_ge_u32 s36, 56
s_cselect_b32 s36, s37, s36
s_xor_b32 s36, s36, s94
s_mul_i32 s39, s36, 458752
s_mul_i32 s41, s35, 16384
s_add_u32 s41, s41, s33
s_mul_i32 s38, s36, 16384
s_mul_i32 s40, s35, 16384
s_add_u32 s40, s40, s32
s_add_u32 m0, s41, 0
s_nop 0
buffer_load_dwordx4 v12, s[8:11], s39 offen  lds
s_add_u32 m0, s41, 1024
s_nop 0
buffer_load_dwordx4 v13, s[8:11], s39 offen  lds
s_add_u32 m0, s41, 2048
s_nop 0
buffer_load_dwordx4 v14, s[8:11], s39 offen  lds
s_add_u32 m0, s41, 3072
s_nop 0
buffer_load_dwordx4 v15, s[8:11], s39 offen  lds
s_add_u32 m0, s40, 0
s_nop 0
buffer_load_dwordx4 v8, s[4:7], s38 offen sc1 lds
s_add_u32 m0, s40, 1024
s_nop 0
buffer_load_dwordx4 v9, s[4:7], s38 offen sc1 lds
s_add_u32 m0, s40, 2048
s_nop 0
buffer_load_dwordx4 v10, s[4:7], s38 offen sc1 lds
s_add_u32 m0, s40, 3072
s_nop 0
buffer_load_dwordx4 v11, s[4:7], s38 offen sc1 lds
s_add_u32 s34, s34, 1
s_add_u32 s35, s35, 1
s_cmp_eq_u32 s35, 4
s_cselect_b32 s35, 0, s35
s_add_u32 s37, s22, 52
s_cmp_gt_u32 s34, s37
s_cselect_b32 s37, 0, 1
s_sub_u32 s37, s34, s37
s_and_b32 s36, s37, 3
s_cmp_eq_u32 s36, s22
s_cselect_b32 s36, 4, 0
s_add_u32 s36, s36, s37
s_cmp_eq_u32 s34, 0
s_cselect_b32 s36, s22, s36
s_add_u32 s36, s36, s23
s_sub_u32 s37, s36, 56
s_cmp_ge_u32 s36, 56
s_cselect_b32 s36, s37, s36
s_xor_b32 s36, s36, s94
s_mul_i32 s39, s36, 458752
s_mul_i32 s41, s35, 16384
s_add_u32 s41, s41, s33
s_mul_i32 s38, s36, 16384
s_mul_i32 s40, s35, 16384
s_add_u32 s40, s40, s32
s_add_u32 m0, s41, 0
s_nop 0
buffer_load_dwordx4 v12, s[8:11], s39 offen  lds
s_add_u32 m0, s41, 1024
s_nop 0
buffer_load_dwordx4 v13, s[8:11], s39 offen  lds
s_add_u32 m0, s41, 2048
s_nop 0
buffer_load_dwordx4 v14, s[8:11], s39 offen  lds
s_add_u32 m0, s41, 3072
s_nop 0
buffer_load_dwordx4 v15, s[8:11], s39 offen  lds
s_add_u32 m0, s40, 0
s_nop 0
buffer_load_dwordx4 v8, s[4:7], s38 offen sc1 lds
s_add_u32 m0, s40, 1024
s_nop 0
buffer_load_dwordx4 v9, s[4:7], s38 offen sc1 lds
s_add_u32 m0, s40, 2048
s_nop 0
buffer_load_dwordx4 v10, s[4:7], s38 offen sc1 lds
s_add_u32 m0, s40, 3072
s_nop 0
buffer_load_dwordx4 v11, s[4:7], s38 offen sc1 lds
s_add_u32 s34, s34, 1
s_add_u32 s35, s35, 1
s_cmp_eq_u32 s35, 4
s_cselect_b32 s35, 0, s35
s_waitcnt vmcnt(28)
s_barrier
s_add_u32 s37, s22, 52
s_cmp_gt_u32 s34, s37
s_cselect_b32 s37, 0, 1
s_sub_u32 s37, s34, s37
s_and_b32 s36, s37, 3
s_cmp_eq_u32 s36, s22
s_cselect_b32 s36, 4, 0
s_add_u32 s36, s36, s37
s_cmp_eq_u32 s34, 0
s_cselect_b32 s36, s22, s36
s_add_u32 s36, s36, s23
s_sub_u32 s37, s36, 56
s_cmp_ge_u32 s36, 56
s_cselect_b32 s36, s37, s36
s_xor_b32 s36, s36, s94
s_mul_i32 s39, s36, 458752
s_mul_i32 s41, s35, 16384
s_add_u32 s41, s41, s33
s_mul_i32 s38, s36, 16384
s_mul_i32 s40, s35, 16384
s_add_u32 s40, s40, s32
s_add_u32 m0, s41, 0
s_nop 0
buffer_load_dwordx4 v12, s[8:11], s39 offen  lds
s_add_u32 m0, s41, 1024
s_nop 0
buffer_load_dwordx4 v13, s[8:11], s39 offen  lds
s_add_u32 m0, s41, 2048
s_nop 0
buffer_load_dwordx4 v14, s[8:11], s39 offen  lds
s_add_u32 m0, s41, 3072
s_nop 0
buffer_load_dwordx4 v15, s[8:11], s39 offen  lds
s_add_u32 m0, s40, 0
s_nop 0
buffer_load_dwordx4 v8, s[4:7], s38 offen sc1 lds
s_add_u32 m0, s40, 1024
s_nop 0
buffer_load_dwordx4 v9, s[4:7], s38 offen sc1 lds
s_add_u32 m0, s40, 2048
s_nop 0
buffer_load_dwordx4 v10, s[4:7], s38 offen sc1 lds
s_add_u32 m0, s40, 3072
s_nop 0
buffer_load_dwordx4 v11, s[4:7], s38 offen sc1 lds
s_add_u32 s34, s34, 1
s_add_u32 s35, s35, 1
s_cmp_eq_u32 s35, 4
s_cselect_b32 s35, 0, s35
s_waitcnt vmcnt(24)
v_lshlrev_b32 v52, 16, v116
v_and_b32 v53, 0xffff0000, v116
v_lshlrev_b32 v60, 16, v120
v_and_b32 v61, 0xffff0000, v120
v_lshlrev_b32 v54, 16, v117
v_and_b32 v55, 0xffff0000, v117
v_lshlrev_b32 v62, 16, v121
v_and_b32 v63, 0xffff0000, v121
v_lshlrev_b32 v56, 16, v118
v_and_b32 v57, 0xffff0000, v118
v_lshlrev_b32 v64, 16, v122
v_and_b32 v65, 0xffff0000, v122
v_lshlrev_b32 v58, 16, v119
v_and_b32 v59, 0xffff0000, v119
v_lshlrev_b32 v66, 16, v123
v_and_b32 v67, 0xffff0000, v123
v_cvt_f32_i32 v84, v84
v_cvt_f32_i32 v85, v85
v_cvt_f32_i32 v86, v86
v_cvt_f32_i32 v87, v87
v_cvt_f32_i32 v88, v88
v_cvt_f32_i32 v89, v89
v_cvt_f32_i32 v90, v90
v_cvt_f32_i32 v91, v91
v_cvt_pk_bf16_f32 v48, v84, v85
v_cvt_pk_bf16_f32 v49, v86, v87
v_cvt_pk_bf16_f32 v50, v88, v89
v_cvt_pk_bf16_f32 v51, v90, v91
v_lshlrev_b32 v84, 16, v48
v_and_b32 v85, 0xffff0000, v48
v_lshlrev_b32 v86, 16, v49
v_and_b32 v87, 0xffff0000, v49
v_lshlrev_b32 v88, 16, v50
v_and_b32 v89, 0xffff0000, v50
v_lshlrev_b32 v90, 16, v51
v_and_b32 v91, 0xffff0000, v51
v_pk_add_f32 v[84:85], v[84:85], v[60:61] neg_lo:[0,1] neg_hi:[0,1]
v_pk_add_f32 v[86:87], v[86:87], v[62:63] neg_lo:[0,1] neg_hi:[0,1]
v_pk_add_f32 v[88:89], v[88:89], v[64:65] neg_lo:[0,1] neg_hi:[0,1]
v_pk_add_f32 v[90:91], v[90:91], v[66:67] neg_lo:[0,1] neg_hi:[0,1]
v_cvt_pk_bf16_f32 v48, v84, v85
v_cvt_pk_bf16_f32 v49, v86, v87
v_cvt_pk_bf16_f32 v50, v88, v89
v_cvt_pk_bf16_f32 v51, v90, v91
v_lshlrev_b32 v84, 16, v48
v_and_b32 v85, 0xffff0000, v48
v_lshlrev_b32 v86, 16, v49
v_and_b32 v87, 0xffff0000, v49
v_lshlrev_b32 v88, 16, v50
v_and_b32 v89, 0xffff0000, v50
v_lshlrev_b32 v90, 16, v51
v_and_b32 v91, 0xffff0000, v51
v_pk_mul_f32 v[84:85], v[84:85], v[52:53]
v_pk_mul_f32 v[86:87], v[86:87], v[54:55]
v_pk_mul_f32 v[88:89], v[88:89], v[56:57]
v_pk_mul_f32 v[90:91], v[90:91], v[58:59]
v_cvt_pk_bf16_f32 v68, v84, v85
v_cvt_pk_bf16_f32 v69, v86, v87
v_cvt_pk_bf16_f32 v70, v88, v89
v_cvt_pk_bf16_f32 v71, v90, v91
buffer_store_dwordx4 v[68:71], v45, s[4:7], s93 offen offset:0 sc1
s_waitcnt vmcnt(17)
s_barrier
s_add_u32 s37, s22, 52
s_cmp_gt_u32 s34, s37
s_cselect_b32 s37, 0, 1
s_sub_u32 s37, s34, s37
s_and_b32 s36, s37, 3
s_cmp_eq_u32 s36, s22
s_cselect_b32 s36, 4, 0
s_add_u32 s36, s36, s37
s_cmp_eq_u32 s34, 0
s_cselect_b32 s36, s22, s36
s_add_u32 s36, s36, s23
s_sub_u32 s37, s36, 56
s_cmp_ge_u32 s36, 56
s_cselect_b32 s36, s37, s36
s_xor_b32 s36, s36, s94
s_mul_i32 s39, s36, 458752
s_mul_i32 s41, s35, 16384
s_add_u32 s41, s41, s33
s_mul_i32 s38, s36, 16384
s_mul_i32 s40, s35, 16384
s_add_u32 s40, s40, s32
s_add_u32 m0, s41, 0
s_nop 0
buffer_load_dwordx4 v12, s[8:11], s39 offen  lds
s_add_u32 m0, s41, 1024
s_nop 0
buffer_load_dwordx4 v13, s[8:11], s39 offen  lds
s_add_u32 m0, s41, 2048
s_nop 0
buffer_load_dwordx4 v14, s[8:11], s39 offen  lds
s_add_u32 m0, s41, 3072
s_nop 0
buffer_load_dwordx4 v15, s[8:11], s39 offen  lds
s_add_u32 m0, s40, 0
s_nop 0
buffer_load_dwordx4 v8, s[4:7], s38 offen sc1 lds
s_add_u32 m0, s40, 1024
s_nop 0
buffer_load_dwordx4 v9, s[4:7], s38 offen sc1 lds
s_add_u32 m0, s40, 2048
s_nop 0
buffer_load_dwordx4 v10, s[4:7], s38 offen sc1 lds
s_add_u32 m0, s40, 3072
s_nop 0
buffer_load_dwordx4 v11, s[4:7], s38 offen sc1 lds
s_add_u32 s34, s34, 1
s_add_u32 s35, s35, 1
s_cmp_eq_u32 s35, 4
s_cselect_b32 s35, 0, s35
v_cvt_f32_i32 v92, v92
v_cvt_f32_i32 v93, v93
v_cvt_f32_i32 v94, v94
v_cvt_f32_i32 v95, v95
v_cvt_f32_i32 v96, v96
v_cvt_f32_i32 v97, v97
v_cvt_f32_i32 v98, v98
v_cvt_f32_i32 v99, v99
v_cvt_pk_bf16_f32 v48, v92, v93
v_cvt_pk_bf16_f32 v49, v94, v95
v_cvt_pk_bf16_f32 v50, v96, v97
v_cvt_pk_bf16_f32 v51, v98, v99
v_lshlrev_b32 v92, 16, v48
v_and_b32 v93, 0xffff0000, v48
v_lshlrev_b32 v94, 16, v49
v_and_b32 v95, 0xffff0000, v49
v_lshlrev_b32 v96, 16, v50
v_and_b32 v97, 0xffff0000, v50
v_lshlrev_b32 v98, 16, v51
v_and_b32 v99, 0xffff0000, v51
v_pk_add_f32 v[92:93], v[92:93], v[60:61] neg_lo:[0,1] neg_hi:[0,1]
v_pk_add_f32 v[94:95], v[94:95], v[62:63] neg_lo:[0,1] neg_hi:[0,1]
v_pk_add_f32 v[96:97], v[96:97], v[64:65] neg_lo:[0,1] neg_hi:[0,1]
v_pk_add_f32 v[98:99], v[98:99], v[66:67] neg_lo:[0,1] neg_hi:[0,1]
v_cvt_pk_bf16_f32 v48, v92, v93
v_cvt_pk_bf16_f32 v49, v94, v95
v_cvt_pk_bf16_f32 v50, v96, v97
v_cvt_pk_bf16_f32 v51, v98, v99
v_lshlrev_b32 v92, 16, v48
v_and_b32 v93, 0xffff0000, v48
v_lshlrev_b32 v94, 16, v49
v_and_b32 v95, 0xffff0000, v49
v_lshlrev_b32 v96, 16, v50
v_and_b32 v97, 0xffff0000, v50
v_lshlrev_b32 v98, 16, v51
v_and_b32 v99, 0xffff0000, v51
v_pk_mul_f32 v[92:93], v[92:93], v[52:53]
v_pk_mul_f32 v[94:95], v[94:95], v[54:55]
v_pk_mul_f32 v[96:97], v[96:97], v[56:57]
v_pk_mul_f32 v[98:99], v[98:99], v[58:59]
v_cvt_pk_bf16_f32 v72, v92, v93
v_cvt_pk_bf16_f32 v73, v94, v95
v_cvt_pk_bf16_f32 v74, v96, v97
v_cvt_pk_bf16_f32 v75, v98, v99
buffer_store_dwordx4 v[72:75], v45, s[4:7], s93 offen offset:128 sc1
s_waitcnt vmcnt(18)
s_barrier
s_add_u32 s37, s22, 52
s_cmp_gt_u32 s34, s37
s_cselect_b32 s37, 0, 1
s_sub_u32 s37, s34, s37
s_and_b32 s36, s37, 3
s_cmp_eq_u32 s36, s22
s_cselect_b32 s36, 4, 0
s_add_u32 s36, s36, s37
s_cmp_eq_u32 s34, 0
s_cselect_b32 s36, s22, s36
s_add_u32 s36, s36, s23
s_sub_u32 s37, s36, 56
s_cmp_ge_u32 s36, 56
s_cselect_b32 s36, s37, s36
s_xor_b32 s36, s36, s94
s_mul_i32 s39, s36, 458752
s_mul_i32 s41, s35, 16384
s_add_u32 s41, s41, s33
s_mul_i32 s38, s36, 16384
s_mul_i32 s40, s35, 16384
s_add_u32 s40, s40, s32
s_add_u32 m0, s41, 0
s_nop 0
buffer_load_dwordx4 v12, s[8:11], s39 offen  lds
s_add_u32 m0, s41, 1024
s_nop 0
buffer_load_dwordx4 v13, s[8:11], s39 offen  lds
s_add_u32 m0, s41, 2048
s_nop 0
buffer_load_dwordx4 v14, s[8:11], s39 offen  lds
s_add_u32 m0, s41, 3072
s_nop 0
buffer_load_dwordx4 v15, s[8:11], s39 offen  lds
s_add_u32 m0, s40, 0
s_nop 0
buffer_load_dwordx4 v8, s[4:7], s38 offen sc1 lds
s_add_u32 m0, s40, 1024
s_nop 0
buffer_load_dwordx4 v9, s[4:7], s38 offen sc1 lds
s_add_u32 m0, s40, 2048
s_nop 0
buffer_load_dwordx4 v10, s[4:7], s38 offen sc1 lds
s_add_u32 m0, s40, 3072
s_nop 0
buffer_load_dwordx4 v11, s[4:7], s38 offen sc1 lds
s_add_u32 s34, s34, 1
s_add_u32 s35, s35, 1
s_cmp_eq_u32 s35, 4
s_cselect_b32 s35, 0, s35
v_cvt_f32_i32 v100, v100
v_cvt_f32_i32 v101, v101
v_cvt_f32_i32 v102, v102
v_cvt_f32_i32 v103, v103
v_cvt_f32_i32 v104, v104
v_cvt_f32_i32 v105, v105
v_cvt_f32_i32 v106, v106
v_cvt_f32_i32 v107, v107
v_cvt_pk_bf16_f32 v48, v100, v101
v_cvt_pk_bf16_f32 v49, v102, v103
v_cvt_pk_bf16_f32 v50, v104, v105
v_cvt_pk_bf16_f32 v51, v106, v107
v_lshlrev_b32 v100, 16, v48
v_and_b32 v101, 0xffff0000, v48
v_lshlrev_b32 v102, 16, v49
v_and_b32 v103, 0xffff0000, v49
v_lshlrev_b32 v104, 16, v50
v_and_b32 v105, 0xffff0000, v50
v_lshlrev_b32 v106, 16, v51
v_and_b32 v107, 0xffff0000, v51
v_pk_add_f32 v[100:101], v[100:101], v[60:61] neg_lo:[0,1] neg_hi:[0,1]
v_pk_add_f32 v[102:103], v[102:103], v[62:63] neg_lo:[0,1] neg_hi:[0,1]
v_pk_add_f32 v[104:105], v[104:105], v[64:65] neg_lo:[0,1] neg_hi:[0,1]
v_pk_add_f32 v[106:107], v[106:107], v[66:67] neg_lo:[0,1] neg_hi:[0,1]
v_cvt_pk_bf16_f32 v48, v100, v101
v_cvt_pk_bf16_f32 v49, v102, v103
v_cvt_pk_bf16_f32 v50, v104, v105
v_cvt_pk_bf16_f32 v51, v106, v107
v_lshlrev_b32 v100, 16, v48
v_and_b32 v101, 0xffff0000, v48
v_lshlrev_b32 v102, 16, v49
v_and_b32 v103, 0xffff0000, v49
v_lshlrev_b32 v104, 16, v50
v_and_b32 v105, 0xffff0000, v50
v_lshlrev_b32 v106, 16, v51
v_and_b32 v107, 0xffff0000, v51
v_pk_mul_f32 v[100:101], v[100:101], v[52:53]
v_pk_mul_f32 v[102:103], v[102:103], v[54:55]
v_pk_mul_f32 v[104:105], v[104:105], v[56:57]
v_pk_mul_f32 v[106:107], v[106:107], v[58:59]
v_cvt_pk_bf16_f32 v76, v100, v101
v_cvt_pk_bf16_f32 v77, v102, v103
v_cvt_pk_bf16_f32 v78, v104, v105
v_cvt_pk_bf16_f32 v79, v106, v107
buffer_store_dwordx4 v[76:79], v45, s[4:7], s93 offen offset:2048 sc1
s_waitcnt vmcnt(19)
s_barrier
s_add_u32 s37, s22, 52
s_cmp_gt_u32 s34, s37
s_cselect_b32 s37, 0, 1
s_sub_u32 s37, s34, s37
s_and_b32 s36, s37, 3
s_cmp_eq_u32 s36, s22
s_cselect_b32 s36, 4, 0
s_add_u32 s36, s36, s37
s_cmp_eq_u32 s34, 0
s_cselect_b32 s36, s22, s36
s_add_u32 s36, s36, s23
s_sub_u32 s37, s36, 56
s_cmp_ge_u32 s36, 56
s_cselect_b32 s36, s37, s36
s_xor_b32 s36, s36, s94
s_mul_i32 s39, s36, 458752
s_mul_i32 s41, s35, 16384
s_add_u32 s41, s41, s33
s_mul_i32 s38, s36, 16384
s_mul_i32 s40, s35, 16384
s_add_u32 s40, s40, s32
s_add_u32 m0, s41, 0
s_nop 0
buffer_load_dwordx4 v12, s[8:11], s39 offen  lds
s_add_u32 m0, s41, 1024
s_nop 0
buffer_load_dwordx4 v13, s[8:11], s39 offen  lds
s_add_u32 m0, s41, 2048
s_nop 0
buffer_load_dwordx4 v14, s[8:11], s39 offen  lds
s_add_u32 m0, s41, 3072
s_nop 0
buffer_load_dwordx4 v15, s[8:11], s39 offen  lds
s_add_u32 m0, s40, 0
s_nop 0
buffer_load_dwordx4 v8, s[4:7], s38 offen sc1 lds
s_add_u32 m0, s40, 1024
s_nop 0
buffer_load_dwordx4 v9, s[4:7], s38 offen sc1 lds
s_add_u32 m0, s40, 2048
s_nop 0
buffer_load_dwordx4 v10, s[4:7], s38 offen sc1 lds
s_add_u32 m0, s40, 3072
s_nop 0
buffer_load_dwordx4 v11, s[4:7], s38 offen sc1 lds
s_add_u32 s34, s34, 1
s_add_u32 s35, s35, 1
s_cmp_eq_u32 s35, 4
s_cselect_b32 s35, 0, s35
v_cvt_f32_i32 v108, v108
v_cvt_f32_i32 v109, v109
v_cvt_f32_i32 v110, v110
v_cvt_f32_i32 v111, v111
v_cvt_f32_i32 v112, v112
v_cvt_f32_i32 v113, v113
v_cvt_f32_i32 v114, v114
v_cvt_f32_i32 v115, v115
v_cvt_pk_bf16_f32 v48, v108, v109
v_cvt_pk_bf16_f32 v49, v110, v111
v_cvt_pk_bf16_f32 v50, v112, v113
v_cvt_pk_bf16_f32 v51, v114, v115
v_lshlrev_b32 v108, 16, v48
v_and_b32 v109, 0xffff0000, v48
v_lshlrev_b32 v110, 16, v49
v_and_b32 v111, 0xffff0000, v49
v_lshlrev_b32 v112, 16, v50
v_and_b32 v113, 0xffff0000, v50
v_lshlrev_b32 v114, 16, v51
v_and_b32 v115, 0xffff0000, v51
v_pk_add_f32 v[108:109], v[108:109], v[60:61] neg_lo:[0,1] neg_hi:[0,1]
v_pk_add_f32 v[110:111], v[110:111], v[62:63] neg_lo:[0,1] neg_hi:[0,1]
v_pk_add_f32 v[112:113], v[112:113], v[64:65] neg_lo:[0,1] neg_hi:[0,1]
v_pk_add_f32 v[114:115], v[114:115], v[66:67] neg_lo:[0,1] neg_hi:[0,1]
v_cvt_pk_bf16_f32 v48, v108, v109
v_cvt_pk_bf16_f32 v49, v110, v111
v_cvt_pk_bf16_f32 v50, v112, v113
v_cvt_pk_bf16_f32 v51, v114, v115
v_lshlrev_b32 v108, 16, v48
v_and_b32 v109, 0xffff0000, v48
v_lshlrev_b32 v110, 16, v49
v_and_b32 v111, 0xffff0000, v49
v_lshlrev_b32 v112, 16, v50
v_and_b32 v113, 0xffff0000, v50
v_lshlrev_b32 v114, 16, v51
v_and_b32 v115, 0xffff0000, v51
v_pk_mul_f32 v[108:109], v[108:109], v[52:53]
v_pk_mul_f32 v[110:111], v[110:111], v[54:55]
v_pk_mul_f32 v[112:113], v[112:113], v[56:57]
v_pk_mul_f32 v[114:115], v[114:115], v[58:59]
v_cvt_pk_bf16_f32 v80, v108, v109
v_cvt_pk_bf16_f32 v81, v110, v111
v_cvt_pk_bf16_f32 v82, v112, v113
v_cvt_pk_bf16_f32 v83, v114, v115
buffer_store_dwordx4 v[80:83], v45, s[4:7], s93 offen offset:2176 sc1
s_waitcnt vmcnt(19)
s_barrier
s_add_u32 s37, s22, 52
s_cmp_gt_u32 s34, s37
s_cselect_b32 s37, 0, 1
s_sub_u32 s37, s34, s37
s_and_b32 s36, s37, 3
s_cmp_eq_u32 s36, s22
s_cselect_b32 s36, 4, 0
s_add_u32 s36, s36, s37
s_cmp_eq_u32 s34, 0
s_cselect_b32 s36, s22, s36
s_add_u32 s36, s36, s23
s_sub_u32 s37, s36, 56
s_cmp_ge_u32 s36, 56
s_cselect_b32 s36, s37, s36
s_xor_b32 s36, s36, s94
s_mul_i32 s39, s36, 458752
s_mul_i32 s41, s35, 16384
s_add_u32 s41, s41, s33
s_mul_i32 s38, s36, 16384
s_mul_i32 s40, s35, 16384
s_add_u32 s40, s40, s32
s_add_u32 m0, s41, 0
s_nop 0
buffer_load_dwordx4 v12, s[8:11], s39 offen  lds
s_add_u32 m0, s41, 1024
s_nop 0
buffer_load_dwordx4 v13, s[8:11], s39 offen  lds
s_add_u32 m0, s41, 2048
s_nop 0
buffer_load_dwordx4 v14, s[8:11], s39 offen  lds
s_add_u32 m0, s41, 3072
s_nop 0
buffer_load_dwordx4 v15, s[8:11], s39 offen  lds
s_add_u32 m0, s40, 0
s_nop 0
buffer_load_dwordx4 v8, s[4:7], s38 offen sc1 lds
s_add_u32 m0, s40, 1024
s_nop 0
buffer_load_dwordx4 v9, s[4:7], s38 offen sc1 lds
s_add_u32 m0, s40, 2048
s_nop 0
buffer_load_dwordx4 v10, s[4:7], s38 offen sc1 lds
s_add_u32 m0, s40, 3072
s_nop 0
buffer_load_dwordx4 v11, s[4:7], s38 offen sc1 lds
s_add_u32 s34, s34, 1
s_add_u32 s35, s35, 1
s_cmp_eq_u32 s35, 4
s_cselect_b32 s35, 0, s35
s_waitcnt vmcnt(18)
s_barrier
s_add_u32 s37, s22, 52
s_cmp_gt_u32 s34, s37
s_cselect_b32 s37, 0, 1
s_sub_u32 s37, s34, s37
s_and_b32 s36, s37, 3
s_cmp_eq_u32 s36, s22
s_cselect_b32 s36, 4, 0
s_add_u32 s36, s36, s37
s_cmp_eq_u32 s34, 0
s_cselect_b32 s36, s22, s36
s_add_u32 s36, s36, s23
s_sub_u32 s37, s36, 56
s_cmp_ge_u32 s36, 56
s_cselect_b32 s36, s37, s36
s_xor_b32 s36, s36, s94
s_mul_i32 s39, s36, 458752
s_mul_i32 s41, s35, 16384
s_add_u32 s41, s41, s33
s_mul_i32 s38, s36, 16384
s_mul_i32 s40, s35, 16384
s_add_u32 s40, s40, s32
s_add_u32 m0, s41, 0
s_nop 0
buffer_load_dwordx4 v12, s[8:11], s39 offen  lds
s_add_u32 m0, s41, 1024
s_nop 0
buffer_load_dwordx4 v13, s[8:11], s39 offen  lds
s_add_u32 m0, s41, 2048
s_nop 0
buffer_load_dwordx4 v14, s[8:11], s39 offen  lds
s_add_u32 m0, s41, 3072
s_nop 0
buffer_load_dwordx4 v15, s[8:11], s39 offen  lds
s_add_u32 m0, s40, 0
s_nop 0
buffer_load_dwordx4 v8, s[4:7], s38 offen sc1 lds
s_add_u32 m0, s40, 1024
s_nop 0
buffer_load_dwordx4 v9, s[4:7], s38 offen sc1 lds
s_add_u32 m0, s40, 2048
s_nop 0
buffer_load_dwordx4 v10, s[4:7], s38 offen sc1 lds
s_add_u32 m0, s40, 3072
s_nop 0
buffer_load_dwordx4 v11, s[4:7], s38 offen sc1 lds
s_add_u32 s34, s34, 1
s_add_u32 s35, s35, 1
s_cmp_eq_u32 s35, 4
s_cselect_b32 s35, 0, s35
s_waitcnt vmcnt(17)
s_waitcnt vmcnt(16)
s_barrier
s_cmp_lg_u32 s16, 0
s_cbranch_scc1 f0_10
v_mov_b32 v48, 0
v_mov_b32 v50, s66
v_mov_b32 v51, s67
s_mov_b64 exec, 1
buffer_store_dwordx2 v[50:51], v48, s[24:27], s30 offen sc1
s_mov_b64 exec, -1
f0_10:
s_add_u32 s37, s22, 52
s_cmp_gt_u32 s34, s37
s_cselect_b32 s37, 0, 1
s_sub_u32 s37, s34, s37
s_and_b32 s36, s37, 3
s_cmp_eq_u32 s36, s22
s_cselect_b32 s36, 4, 0
s_add_u32 s36, s36, s37
s_cmp_eq_u32 s34, 0
s_cselect_b32 s36, s22, s36
s_add_u32 s36, s36, s23
s_sub_u32 s37, s36, 56
s_cmp_ge_u32 s36, 56
s_cselect_b32 s36, s37, s36
s_xor_b32 s36, s36, s94
s_mul_i32 s39, s36, 458752
s_mul_i32 s41, s35, 16384
s_add_u32 s41, s41, s33
s_mul_i32 s38, s36, 16384
s_mul_i32 s40, s35, 16384
s_add_u32 s40, s40, s32
s_add_u32 m0, s41, 0
s_nop 0
buffer_load_dwordx4 v12, s[8:11], s39 offen  lds
s_add_u32 m0, s41, 1024
s_nop 0
buffer_load_dwordx4 v13, s[8:11], s39 offen  lds
s_add_u32 m0, s41, 2048
s_nop 0
buffer_load_dwordx4 v14, s[8:11], s39 offen  lds
s_add_u32 m0, s41, 3072
s_nop 0
buffer_load_dwordx4 v15, s[8:11], s39 offen  lds
s_add_u32 m0, s40, 0
s_nop 0
buffer_load_dwordx4 v8, s[4:7], s38 offen sc1 lds
s_add_u32 m0, s40, 1024
s_nop 0
buffer_load_dwordx4 v9, s[4:7], s38 offen sc1 lds
s_add_u32 m0, s40, 2048
s_nop 0
buffer_load_dwordx4 v10, s[4:7], s38 offen sc1 lds
s_add_u32 m0, s40, 3072
s_nop 0
buffer_load_dwordx4 v11, s[4:7], s38 offen sc1 lds
s_add_u32 s34, s34, 1
s_add_u32 s35, s35, 1
s_cmp_eq_u32 s35, 4
s_cselect_b32 s35, 0, s35
s_waitcnt vmcnt(16)
s_barrier
p1_pm_11:
s_add_u32 s37, s22, 52
s_cmp_gt_u32 s34, s37
s_cselect_b32 s37, 0, 1
s_sub_u32 s37, s34, s37
s_and_b32 s36, s37, 3
s_cmp_eq_u32 s36, s22
s_cselect_b32 s36, 4, 0
s_add_u32 s36, s36, s37
s_cmp_eq_u32 s34, 0
s_cselect_b32 s36, s22, s36
s_add_u32 s36, s36, s23
s_sub_u32 s37, s36, 56
s_cmp_ge_u32 s36, 56
s_cselect_b32 s36, s37, s36
s_xor_b32 s36, s36, s94
s_mul_i32 s39, s36, 458752
s_mul_i32 s41, s35, 16384
s_add_u32 s41, s41, s33
s_mul_i32 s38, s36, 16384
s_mul_i32 s40, s35, 16384
s_add_u32 s40, s40, s32
s_add_u32 m0, s41, 0
s_nop 0
buffer_load_dwordx4 v12, s[8:11], s39 offen  lds
s_add_u32 m0, s41, 1024
s_nop 0
buffer_load_dwordx4 v13, s[8:11], s39 offen  lds
s_add_u32 m0, s41, 2048
s_nop 0
buffer_load_dwordx4 v14, s[8:11], s39 offen  lds
s_add_u32 m0, s41, 3072
s_nop 0
buffer_load_dwordx4 v15, s[8:11], s39 offen  lds
s_add_u32 m0, s40, 0
s_nop 0
buffer_load_dwordx4 v8, s[4:7], s38 offen sc1 lds
s_add_u32 m0, s40, 1024
s_nop 0
buffer_load_dwordx4 v9, s[4:7], s38 offen sc1 lds
s_add_u32 m0, s40, 2048
s_nop 0
buffer_load_dwordx4 v10, s[4:7], s38 offen sc1 lds
s_add_u32 m0, s40, 3072
s_nop 0
buffer_load_dwordx4 v11, s[4:7], s38 offen sc1 lds
s_add_u32 s34, s34, 1
s_add_u32 s35, s35, 1
s_cmp_eq_u32 s35, 4
s_cselect_b32 s35, 0, s35
s_waitcnt vmcnt(16)
s_barrier
s_cmp_lt_u32 s34, 18
s_cbranch_scc1 p1_pm_11
v_min_u32 v24, 27, v1
v_lshlrev_b32 v24, 3, v24
buffer_load_dwordx2 v[26:27], v24, s[24:27], s29 offen sc1
s_add_u32 s37, s22, 52
s_cmp_gt_u32 s34, s37
s_cselect_b32 s37, 0, 1
s_sub_u32 s37, s34, s37
s_and_b32 s36, s37, 3
s_cmp_eq_u32 s36, s22
s_cselect_b32 s36, 4, 0
s_add_u32 s36, s36, s37
s_cmp_eq_u32 s34, 0
s_cselect_b32 s36, s22, s36
s_add_u32 s36, s36, s23
s_sub_u32 s37, s36, 56
s_cmp_ge_u32 s36, 56
s_cselect_b32 s36, s37, s36
s_xor_b32 s36, s36, s94
s_mul_i32 s39, s36, 458752
s_mul_i32 s41, s35, 16384
s_add_u32 s41, s41, s33
s_mul_i32 s38, s36, 16384
s_mul_i32 s40, s35, 16384
s_add_u32 s40, s40, s32
s_add_u32 m0, s41, 0
s_nop 0
buffer_load_dwordx4 v12, s[8:11], s39 offen  lds
s_add_u32 m0, s41, 1024
s_nop 0
buffer_load_dwordx4 v13, s[8:11], s39 offen  lds
s_add_u32 m0, s41, 2048
s_nop 0
buffer_load_dwordx4 v14, s[8:11], s39 offen  lds
s_add_u32 m0, s41, 3072
s_nop 0
buffer_load_dwordx4 v15, s[8:11], s39 offen  lds
s_add_u32 m0, s40, 0
s_nop 0
buffer_load_dwordx4 v8, s[4:7], s38 offen sc1 lds
s_add_u32 m0, s40, 1024
s_nop 0
buffer_load_dwordx4 v9, s[4:7], s38 offen sc1 lds
s_add_u32 m0, s40, 2048
s_nop 0
buffer_load_dwordx4 v10, s[4:7], s38 offen sc1 lds
s_add_u32 m0, s40, 3072
s_nop 0
buffer_load_dwordx4 v11, s[4:7], s38 offen sc1 lds
s_add_u32 s34, s34, 1
s_add_u32 s35, s35, 1
s_cmp_eq_u32 s35, 4
s_cselect_b32 s35, 0, s35
s_waitcnt vmcnt(17)
s_barrier
s_add_u32 s37, s22, 52
s_cmp_gt_u32 s34, s37
s_cselect_b32 s37, 0, 1
s_sub_u32 s37, s34, s37
s_and_b32 s36, s37, 3
s_cmp_eq_u32 s36, s22
s_cselect_b32 s36, 4, 0
s_add_u32 s36, s36, s37
s_cmp_eq_u32 s34, 0
s_cselect_b32 s36, s22, s36
s_add_u32 s36, s36, s23
s_sub_u32 s37, s36, 56
s_cmp_ge_u32 s36, 56
s_cselect_b32 s36, s37, s36
s_xor_b32 s36, s36, s94
s_mul_i32 s39, s36, 458752
s_mul_i32 s41, s35, 16384
s_add_u32 s41, s41, s33
s_mul_i32 s38, s36, 16384
s_mul_i32 s40, s35, 16384
s_add_u32 s40, s40, s32
s_add_u32 m0, s41, 0
s_nop 0
buffer_load_dwordx4 v12, s[8:11], s39 offen  lds
s_add_u32 m0, s41, 1024
s_nop 0
buffer_load_dwordx4 v13, s[8:11], s39 offen  lds
s_add_u32 m0, s41, 2048
s_nop 0
buffer_load_dwordx4 v14, s[8:11], s39 offen  lds
s_add_u32 m0, s41, 3072
s_nop 0
buffer_load_dwordx4 v15, s[8:11], s39 offen  lds
s_add_u32 m0, s40, 0
s_nop 0
buffer_load_dwordx4 v8, s[4:7], s38 offen sc1 lds
s_add_u32 m0, s40, 1024
s_nop 0
buffer_load_dwordx4 v9, s[4:7], s38 offen sc1 lds
s_add_u32 m0, s40, 2048
s_nop 0
buffer_load_dwordx4 v10, s[4:7], s38 offen sc1 lds
s_add_u32 m0, s40, 3072
s_nop 0
buffer_load_dwordx4 v11, s[4:7], s38 offen sc1 lds
s_add_u32 s34, s34, 1
s_add_u32 s35, s35, 1
s_cmp_eq_u32 s35, 4
s_cselect_b32 s35, 0, s35
s_waitcnt vmcnt(17)
s_waitcnt vmcnt(16)
v_cmp_ne_u64 vcc, s[66:67], v[26:27]
s_nop 4
s_cmp_eq_u64 vcc, 0
s_cbranch_scc1 pd_13
s_mov_b32 s19, 32768
pl_12:
buffer_load_dwordx2 v[26:27], v24, s[24:27], s29 offen sc1
s_waitcnt vmcnt(0)
v_cmp_ne_u64 vcc, s[66:67], v[26:27]
s_nop 4
s_cmp_eq_u64 vcc, 0
s_cbranch_scc1 pd_13
s_add_u32 s100, s100, 1
s_sleep 2
s_sub_u32 s19, s19, 1
s_cmp_lg_u32 s19, 0
s_cbranch_scc1 pl_12
pd_13:
s_barrier
p1_pm_14:
s_add_u32 s37, s22, 52
s_cmp_gt_u32 s34, s37
s_cselect_b32 s37, 0, 1
s_sub_u32 s37, s34, s37
s_and_b32 s36, s37, 3
s_cmp_eq_u32 s36, s22
s_cselect_b32 s36, 4, 0
s_add_u32 s36, s36, s37
s_cmp_eq_u32 s34, 0
s_cselect_b32 s36, s22, s36
s_add_u32 s36, s36, s23
s_sub_u32 s37, s36, 56
s_cmp_ge_u32 s36, 56
s_cselect_b32 s36, s37, s36
s_xor_b32 s36, s36, s94
s_mul_i32 s39, s36, 458752
s_mul_i32 s41, s35, 16384
s_add_u32 s41, s41, s33
s_mul_i32 s38, s36, 16384
s_mul_i32 s40, s35, 16384
s_add_u32 s40, s40, s32
s_add_u32 m0, s41, 0
s_nop 0
buffer_load_dwordx4 v12, s[8:11], s39 offen  lds
s_add_u32 m0, s41, 1024
s_nop 0
buffer_load_dwordx4 v13, s[8:11], s39 offen  lds
s_add_u32 m0, s41, 2048
s_nop 0
buffer_load_dwordx4 v14, s[8:11], s39 offen  lds
s_add_u32 m0, s41, 3072
s_nop 0
buffer_load_dwordx4 v15, s[8:11], s39 offen  lds
s_add_u32 m0, s40, 0
s_nop 0
buffer_load_dwordx4 v8, s[4:7], s38 offen sc1 lds
s_add_u32 m0, s40, 1024
s_nop 0
buffer_load_dwordx4 v9, s[4:7], s38 offen sc1 lds
s_add_u32 m0, s40, 2048
s_nop 0
buffer_load_dwordx4 v10, s[4:7], s38 offen sc1 lds
s_add_u32 m0, s40, 3072
s_nop 0
buffer_load_dwordx4 v11, s[4:7], s38 offen sc1 lds
s_add_u32 s34, s34, 1
s_add_u32 s35, s35, 1
s_cmp_eq_u32 s35, 4
s_cselect_b32 s35, 0, s35
s_waitcnt vmcnt(16)
s_barrier
s_cmp_lt_u32 s34, 50
s_cbranch_scc1 p1_pm_14
s_lshl_b32 s28, s44, 8
s_lshr_b32 s19, s44, 2
s_lshl_b32 s19, s19, 7
s_add_u32 s28, s28, s19
s_add_u32 s28, s28, 8192
v_min_u32 v24, 15, v1
v_lshlrev_b32 v24, 3, v24
buffer_load_dwordx2 v[26:27], v24, s[24:27], s28 offen sc1
s_add_u32 s37, s22, 52
s_cmp_gt_u32 s34, s37
s_cselect_b32 s37, 0, 1
s_sub_u32 s37, s34, s37
s_and_b32 s36, s37, 3
s_cmp_eq_u32 s36, s22
s_cselect_b32 s36, 4, 0
s_add_u32 s36, s36, s37
s_cmp_eq_u32 s34, 0
s_cselect_b32 s36, s22, s36
s_add_u32 s36, s36, s23
s_sub_u32 s37, s36, 56
s_cmp_ge_u32 s36, 56
s_cselect_b32 s36, s37, s36
s_xor_b32 s36, s36, s94
s_mul_i32 s39, s36, 458752
s_mul_i32 s41, s35, 16384
s_add_u32 s41, s41, s33
s_mul_i32 s38, s36, 16384
s_mul_i32 s40, s35, 16384
s_add_u32 s40, s40, s32
s_add_u32 m0, s41, 0
s_nop 0
buffer_load_dwordx4 v12, s[8:11], s39 offen  lds
s_add_u32 m0, s41, 1024
s_nop 0
buffer_load_dwordx4 v13, s[8:11], s39 offen  lds
s_add_u32 m0, s41, 2048
s_nop 0
buffer_load_dwordx4 v14, s[8:11], s39 offen  lds
s_add_u32 m0, s41, 3072
s_nop 0
buffer_load_dwordx4 v15, s[8:11], s39 offen  lds
s_add_u32 m0, s40, 0
s_nop 0
buffer_load_dwordx4 v8, s[4:7], s38 offen sc1 lds
s_add_u32 m0, s40, 1024
s_nop 0
buffer_load_dwordx4 v9, s[4:7], s38 offen sc1 lds
s_add_u32 m0, s40, 2048
s_nop 0
buffer_load_dwordx4 v10, s[4:7], s38 offen sc1 lds
s_add_u32 m0, s40, 3072
s_nop 0
buffer_load_dwordx4 v11, s[4:7], s38 offen sc1 lds
s_add_u32 s34, s34, 1
s_add_u32 s35, s35, 1
s_cmp_eq_u32 s35, 4
s_cselect_b32 s35, 0, s35
s_waitcnt vmcnt(17)
s_barrier
s_add_u32 s37, s22, 52
s_cmp_gt_u32 s34, s37
s_cselect_b32 s37, 0, 1
s_sub_u32 s37, s34, s37
s_and_b32 s36, s37, 3
s_cmp_eq_u32 s36, s22
s_cselect_b32 s36, 4, 0
s_add_u32 s36, s36, s37
s_cmp_eq_u32 s34, 0
s_cselect_b32 s36, s22, s36
s_add_u32 s36, s36, s23
s_sub_u32 s37, s36, 56
s_cmp_ge_u32 s36, 56
s_cselect_b32 s36, s37, s36
s_xor_b32 s36, s36, s94
s_mul_i32 s39, s36, 458752
s_mul_i32 s41, s35, 16384
s_add_u32 s41, s41, s33
s_mul_i32 s38, s36, 16384
s_mul_i32 s40, s35, 16384
s_add_u32 s40, s40, s32
s_add_u32 m0, s41, 0
s_nop 0
buffer_load_dwordx4 v12, s[8:11], s39 offen  lds
s_add_u32 m0, s41, 1024
s_nop 0
buffer_load_dwordx4 v13, s[8:11], s39 offen  lds
s_add_u32 m0, s41, 2048
s_nop 0
buffer_load_dwordx4 v14, s[8:11], s39 offen  lds
s_add_u32 m0, s41, 3072
s_nop 0
buffer_load_dwordx4 v15, s[8:11], s39 offen  lds
s_add_u32 m0, s40, 0
s_nop 0
buffer_load_dwordx4 v8, s[4:7], s38 offen sc1 lds
s_add_u32 m0, s40, 1024
s_nop 0
buffer_load_dwordx4 v9, s[4:7], s38 offen sc1 lds
s_add_u32 m0, s40, 2048
s_nop 0
buffer_load_dwordx4 v10, s[4:7], s38 offen sc1 lds
s_add_u32 m0, s40, 3072
s_nop 0
buffer_load_dwordx4 v11, s[4:7], s38 offen sc1 lds
s_add_u32 s34, s34, 1
s_add_u32 s35, s35, 1
s_cmp_eq_u32 s35, 4
s_cselect_b32 s35, 0, s35
s_waitcnt vmcnt(17)
s_barrier
s_add_u32 s37, s22, 52
s_cmp_gt_u32 s34, s37
s_cselect_b32 s37, 0, 1
s_sub_u32 s37, s34, s37
s_and_b32 s36, s37, 3
s_cmp_eq_u32 s36, s22
s_cselect_b32 s36, 4, 0
s_add_u32 s36, s36, s37
s_cmp_eq_u32 s34, 0
s_cselect_b32 s36, s22, s36
s_add_u32 s36, s36, s23
s_sub_u32 s37, s36, 56
s_cmp_ge_u32 s36, 56
s_cselect_b32 s36, s37, s36
s_xor_b32 s36, s36, s94
s_mul_i32 s39, s36, 458752
s_mul_i32 s41, s35, 16384
s_add_u32 s41, s41, s33
s_mul_i32 s38, s36, 16384
s_mul_i32 s40, s35, 16384
s_add_u32 s40, s40, s32
s_add_u32 m0, s41, 0
s_nop 0
buffer_load_dwordx4 v12, s[8:11], s39 offen  lds
s_add_u32 m0, s41, 1024
s_nop 0
buffer_load_dwordx4 v13, s[8:11], s39 offen  lds
s_add_u32 m0, s41, 2048
s_nop 0
buffer_load_dwordx4 v14, s[8:11], s39 offen  lds
s_add_u32 m0, s41, 3072
s_nop 0
buffer_load_dwordx4 v15, s[8:11], s39 offen  lds
s_add_u32 m0, s40, 0
s_nop 0
buffer_load_dwordx4 v8, s[4:7], s38 offen sc1 lds
s_add_u32 m0, s40, 1024
s_nop 0
buffer_load_dwordx4 v9, s[4:7], s38 offen sc1 lds
s_add_u32 m0, s40, 2048
s_nop 0
buffer_load_dwordx4 v10, s[4:7], s38 offen sc1 lds
s_add_u32 m0, s40, 3072
s_nop 0
buffer_load_dwordx4 v11, s[4:7], s38 offen sc1 lds
s_add_u32 s34, s34, 1
s_add_u32 s35, s35, 1
s_cmp_eq_u32 s35, 4
s_cselect_b32 s35, 0, s35
s_waitcnt vmcnt(16)
s_waitcnt vmcnt(24)
v_cmp_ne_u64 vcc, s[66:67], v[26:27]
s_nop 4
s_cmp_eq_u64 vcc, 0
s_cbranch_scc1 pd_16
s_mov_b32 s19, 32768
pl_15:
buffer_load_dwordx2 v[26:27], v24, s[24:27], s28 offen sc1
s_waitcnt vmcnt(0)
v_cmp_ne_u64 vcc, s[66:67], v[26:27]
s_nop 4
s_cmp_eq_u64 vcc, 0
s_cbranch_scc1 pd_16
s_add_u32 s100, s100, 1
s_sleep 2
s_sub_u32 s19, s19, 1
s_cmp_lg_u32 s19, 0
s_cbranch_scc1 pl_15
pd_16:
s_barrier
p1_pm_17:
s_add_u32 s37, s22, 52
s_cmp_gt_u32 s34, s37
s_cselect_b32 s37, 0, 1
s_sub_u32 s37, s34, s37
s_and_b32 s36, s37, 3
s_cmp_eq_u32 s36, s22
s_cselect_b32 s36, 4, 0
s_add_u32 s36, s36, s37
s_cmp_eq_u32 s34, 0
s_cselect_b32 s36, s22, s36
s_add_u32 s36, s36, s23
s_sub_u32 s37, s36, 56
s_cmp_ge_u32 s36, 56
s_cselect_b32 s36, s37, s36
s_xor_b32 s36, s36, s94
s_mul_i32 s39, s36, 458752
s_mul_i32 s41, s35, 16384
s_add_u32 s41, s41, s33
s_mul_i32 s38, s36, 16384
s_mul_i32 s40, s35, 16384
s_add_u32 s40, s40, s32
s_add_u32 m0, s41, 0
s_nop 0
buffer_load_dwordx4 v12, s[8:11], s39 offen  lds
s_add_u32 m0, s41, 1024
s_nop 0
buffer_load_dwordx4 v13, s[8:11], s39 offen  lds
s_add_u32 m0, s41, 2048
s_nop 0
buffer_load_dwordx4 v14, s[8:11], s39 offen  lds
s_add_u32 m0, s41, 3072
s_nop 0
buffer_load_dwordx4 v15, s[8:11], s39 offen  lds
s_add_u32 m0, s40, 0
s_nop 0
buffer_load_dwordx4 v8, s[4:7], s38 offen sc1 lds
s_add_u32 m0, s40, 1024
s_nop 0
buffer_load_dwordx4 v9, s[4:7], s38 offen sc1 lds
s_add_u32 m0, s40, 2048
s_nop 0
buffer_load_dwordx4 v10, s[4:7], s38 offen sc1 lds
s_add_u32 m0, s40, 3072
s_nop 0
buffer_load_dwordx4 v11, s[4:7], s38 offen sc1 lds
s_add_u32 s34, s34, 1
s_add_u32 s35, s35, 1
s_cmp_eq_u32 s35, 4
s_cselect_b32 s35, 0, s35
s_waitcnt vmcnt(16)
s_barrier
s_cmp_lt_u32 s34, 56
s_cbranch_scc1 p1_pm_17
s_and_b32 s22, s44, 3
s_lshl_b32 s22, s22, 1
s_lshr_b32 s23, s44, 2
s_lshl_b32 s23, s23, 3
s_lshl_b32 s21, s45, 18
s_lshl_b32 s20, s44, 19
s_bfe_u32 s47, s43, 0x10002
s_add_u32 s4, s64, 16777216
s_addc_u32 s5, s65, 0
s_mov_b32 s6, 4194304
s_mov_b32 s7, 0x20000
s_add_u32 s8, s64, 8388608
s_addc_u32 s9, s65, 0
s_mov_b32 s10, 7340032
s_mov_b32 s11, 0x20000
s_mov_b32 s12, s60
s_mov_b32 s13, s61
s_mov_b32 s14, 14680064
s_mov_b32 s15, 0x20000
v_and_b32 v1, 63, v0
s_mul_i32 s19, s17, 8192
s_add_u32 s19, s19, s20
v_lshl_add_u32 v8, v1, 4, s19
v_add_u32 v9, 1024, v8
v_add_u32 v10, 2048, v8
v_add_u32 v11, 3072, v8
v_add_u32 v12, 4096, v8
v_add_u32 v13, 5120, v8
v_add_u32 v14, 6144, v8
v_add_u32 v15, 7168, v8
s_mul_i32 s19, s17, 4096
s_add_u32 s19, s19, s21
v_lshl_add_u32 v16, v1, 4, s19
v_add_u32 v17, 1024, v16
v_add_u32 v18, 2048, v16
v_add_u32 v19, 3072, v16
s_mul_i32 s32, s17, 8192
s_add_u32 s32, s32, 131072
s_mul_i32 s33, s17, 4096
s_add_u32 s33, s33, 65536
s_mov_b32 s34, 0
s_mov_b32 s35, 0
s_xor_b32 s29, s28, 128
s_and_b32 s30, s95, -32
s_xor_b32 s31, s30, 32
s_xor_b32 s36, s34, s47
s_add_u32 s36, s36, s22
s_and_b32 s36, s36, 7
s_and_b32 s37, s34, 8
s_xor_b32 s37, s37, s23
s_or_b32 s36, s36, s37
s_mul_i32 s38, s36, 32768
s_mul_i32 s40, s35, 32768
s_add_u32 s40, s40, s32
s_sub_u32 s37, s40, 163840
s_cmp_ge_u32 s40, 163840
s_cselect_b32 s40, s37, s40
s_add_u32 m0, s40, 0
s_nop 0
buffer_load_dwordx4 v8, s[4:7], s38 offen sc1 lds
s_add_u32 m0, s40, 1024
s_nop 0
buffer_load_dwordx4 v9, s[4:7], s38 offen sc1 lds
s_add_u32 m0, s40, 2048
s_nop 0
buffer_load_dwordx4 v10, s[4:7], s38 offen sc1 lds
s_add_u32 m0, s40, 3072
s_nop 0
buffer_load_dwordx4 v11, s[4:7], s38 offen sc1 lds
s_add_u32 m0, s40, 4096
s_nop 0
buffer_load_dwordx4 v12, s[4:7], s38 offen sc1 lds
s_add_u32 m0, s40, 5120
s_nop 0
buffer_load_dwordx4 v13, s[4:7], s38 offen sc1 lds
s_add_u32 m0, s40, 6144
s_nop 0
buffer_load_dwordx4 v14, s[4:7], s38 offen sc1 lds
s_add_u32 m0, s40, 7168
s_nop 0
buffer_load_dwordx4 v15, s[4:7], s38 offen sc1 lds
s_add_u32 s34, s34, 1
s_add_u32 s35, s35, 1
s_cmp_eq_u32 s35, 3
s_cselect_b32 s35, 0, s35
s_waitcnt vmcnt(16)
s_barrier
s_xor_b32 s36, s34, s47
s_add_u32 s36, s36, s22
s_and_b32 s36, s36, 7
s_and_b32 s37, s34, 8
s_xor_b32 s37, s37, s23
s_or_b32 s36, s36, s37
s_mul_i32 s38, s36, 32768
s_mul_i32 s40, s35, 32768
s_add_u32 s40, s40, s32
s_sub_u32 s37, s40, 163840
s_cmp_ge_u32 s40, 163840
s_cselect_b32 s40, s37, s40
s_add_u32 m0, s40, 0
s_nop 0
buffer_load_dwordx4 v8, s[4:7], s38 offen sc1 lds
s_add_u32 m0, s40, 1024
s_nop 0
buffer_load_dwordx4 v9, s[4:7], s38 offen sc1 lds
s_add_u32 m0, s40, 2048
s_nop 0
buffer_load_dwordx4 v10, s[4:7], s38 offen sc1 lds
s_add_u32 m0, s40, 3072
s_nop 0
buffer_load_dwordx4 v11, s[4:7], s38 offen sc1 lds
s_add_u32 m0, s40, 4096
s_nop 0
buffer_load_dwordx4 v12, s[4:7], s38 offen sc1 lds
s_add_u32 m0, s40, 5120
s_nop 0
buffer_load_dwordx4 v13, s[4:7], s38 offen sc1 lds
s_add_u32 m0, s40, 6144
s_nop 0
buffer_load_dwordx4 v14, s[4:7], s38 offen sc1 lds
s_add_u32 m0, s40, 7168
s_nop 0
buffer_load_dwordx4 v15, s[4:7], s38 offen sc1 lds
s_add_u32 s34, s34, 1
s_add_u32 s35, s35, 1
s_cmp_eq_u32 s35, 3
s_cselect_b32 s35, 0, s35
s_waitcnt vmcnt(16)
s_barrier
s_barrier
s_barrier
s_waitcnt vmcnt(0)
s_barrier
s_cmp_lg_u32 s16, 0
s_cbranch_scc1 f0_18
v_mov_b32 v28, 0
v_mov_b32 v30, s66
v_mov_b32 v31, s67
s_mov_b64 exec, 1
buffer_store_dwordx2 v[30:31], v28, s[24:27], s95 offen sc1
s_mov_b64 exec, -1
f0_18:
s_barrier
s_xor_b32 s36, s34, s47
s_add_u32 s36, s36, s22
s_and_b32 s36, s36, 7
s_and_b32 s37, s34, 8
s_xor_b32 s37, s37, s23
s_or_b32 s36, s36, s37
s_mul_i32 s38, s36, 32768
s_mul_i32 s40, s35, 32768
s_add_u32 s40, s40, s32
s_sub_u32 s37, s40, 163840
s_cmp_ge_u32 s40, 163840
s_cselect_b32 s40, s37, s40
s_add_u32 m0, s40, 0
s_nop 0
buffer_load_dwordx4 v8, s[4:7], s38 offen sc1 lds
s_add_u32 m0, s40, 1024
s_nop 0
buffer_load_dwordx4 v9, s[4:7], s38 offen sc1 lds
s_add_u32 m0, s40, 2048
s_nop 0
buffer_load_dwordx4 v10, s[4:7], s38 offen sc1 lds
s_add_u32 m0, s40, 3072
s_nop 0
buffer_load_dwordx4 v11, s[4:7], s38 offen sc1 lds
s_add_u32 m0, s40, 4096
s_nop 0
buffer_load_dwordx4 v12, s[4:7], s38 offen sc1 lds
s_add_u32 m0, s40, 5120
s_nop 0
buffer_load_dwordx4 v13, s[4:7], s38 offen sc1 lds
s_add_u32 m0, s40, 6144
s_nop 0
buffer_load_dwordx4 v14, s[4:7], s38 offen sc1 lds
s_add_u32 m0, s40, 7168
s_nop 0
buffer_load_dwordx4 v15, s[4:7], s38 offen sc1 lds
v_min_u32 v24, 3, v1
v_lshlrev_b32 v24, 3, v24
s_mov_b32 s19, 32768
pl_19:
buffer_load_dwordx2 v[26:27], v24, s[24:27], s30 offen sc1
s_waitcnt vmcnt(0)
v_cmp_ne_u64 vcc, s[66:67], v[26:27]
s_nop 4
s_cmp_eq_u64 vcc, 0
s_cbranch_scc1 pd_20
s_add_u32 s100, s100, 1
s_sleep 2
s_sub_u32 s19, s19, 1
s_cmp_lg_u32 s19, 0
s_cbranch_scc1 pl_19
pd_20:
s_xor_b32 s36, s34, s47
s_add_u32 s36, s36, s22
s_and_b32 s36, s36, 7
s_and_b32 s37, s34, 8
s_xor_b32 s37, s37, s23
s_or_b32 s36, s36, s37
s_mul_i32 s39, s36, 16384
s_mul_i32 s41, s35, 16384
s_add_u32 s41, s41, s33
s_add_u32 m0, s41, 0
s_nop 0
buffer_load_dwordx4 v16, s[8:11], s39 offen sc1 lds
s_add_u32 m0, s41, 1024
s_nop 0
buffer_load_dwordx4 v17, s[8:11], s39 offen sc1 lds
s_add_u32 m0, s41, 2048
s_nop 0
buffer_load_dwordx4 v18, s[8:11], s39 offen sc1 lds
s_add_u32 m0, s41, 3072
s_nop 0
buffer_load_dwordx4 v19, s[8:11], s39 offen sc1 lds
s_add_u32 s34, s34, 1
s_add_u32 s35, s35, 1
s_cmp_eq_u32 s35, 3
s_cselect_b32 s35, 0, s35
p2_pm_21:
s_xor_b32 s36, s34, s47
s_add_u32 s36, s36, s22
s_and_b32 s36, s36, 7
s_and_b32 s37, s34, 8
s_xor_b32 s37, s37, s23
s_or_b32 s36, s36, s37
s_mul_i32 s39, s36, 16384
s_mul_i32 s41, s35, 16384
s_add_u32 s41, s41, s33
s_mul_i32 s38, s36, 32768
s_mul_i32 s40, s35, 32768
s_add_u32 s40, s40, s32
s_sub_u32 s37, s40, 163840
s_cmp_ge_u32 s40, 163840
s_cselect_b32 s40, s37, s40
s_add_u32 m0, s41, 0
s_nop 0
buffer_load_dwordx4 v16, s[8:11], s39 offen sc1 lds
s_add_u32 m0, s41, 1024
s_nop 0
buffer_load_dwordx4 v17, s[8:11], s39 offen sc1 lds
s_add_u32 m0, s41, 2048
s_nop 0
buffer_load_dwordx4 v18, s[8:11], s39 offen sc1 lds
s_add_u32 m0, s41, 3072
s_nop 0
buffer_load_dwordx4 v19, s[8:11], s39 offen sc1 lds
s_add_u32 m0, s40, 0
s_nop 0
buffer_load_dwordx4 v8, s[4:7], s38 offen sc1 lds
s_add_u32 m0, s40, 1024
s_nop 0
buffer_load_dwordx4 v9, s[4:7], s38 offen sc1 lds
s_add_u32 m0, s40, 2048
s_nop 0
buffer_load_dwordx4 v10, s[4:7], s38 offen sc1 lds
s_add_u32 m0, s40, 3072
s_nop 0
buffer_load_dwordx4 v11, s[4:7], s38 offen sc1 lds
s_add_u32 m0, s40, 4096
s_nop 0
buffer_load_dwordx4 v12, s[4:7], s38 offen sc1 lds
s_add_u32 m0, s40, 5120
s_nop 0
buffer_load_dwordx4 v13, s[4:7], s38 offen sc1 lds
s_add_u32 m0, s40, 6144
s_nop 0
buffer_load_dwordx4 v14, s[4:7], s38 offen sc1 lds
s_add_u32 m0, s40, 7168
s_nop 0
buffer_load_dwordx4 v15, s[4:7], s38 offen sc1 lds
s_add_u32 s34, s34, 1
s_add_u32 s35, s35, 1
s_cmp_eq_u32 s35, 3
s_cselect_b32 s35, 0, s35
s_waitcnt vmcnt(12)
s_barrier
s_cmp_lt_u32 s34, 7
s_cbranch_scc1 p2_pm_21
v_min_u32 v24, 15, v1
v_lshlrev_b32 v24, 3, v24
buffer_load_dwordx2 v[26:27], v24, s[24:27], s29 offen sc1
v_min_u32 v32, 3, v1
v_lshlrev_b32 v32, 3, v32
buffer_load_dwordx2 v[34:35], v32, s[24:27], s31 offen sc1
s_xor_b32 s36, s34, s47
s_add_u32 s36, s36, s22
s_and_b32 s36, s36, 7
s_and_b32 s37, s34, 8
s_xor_b32 s37, s37, s23
s_or_b32 s36, s36, s37
s_mul_i32 s39, s36, 16384
s_mul_i32 s41, s35, 16384
s_add_u32 s41, s41, s33
s_mul_i32 s38, s36, 32768
s_mul_i32 s40, s35, 32768
s_add_u32 s40, s40, s32
s_sub_u32 s37, s40, 163840
s_cmp_ge_u32 s40, 163840
s_cselect_b32 s40, s37, s40
s_add_u32 m0, s41, 0
s_nop 0
buffer_load_dwordx4 v16, s[8:11], s39 offen sc1 lds
s_add_u32 m0, s41, 1024
s_nop 0
buffer_load_dwordx4 v17, s[8:11], s39 offen sc1 lds
s_add_u32 m0, s41, 2048
s_nop 0
buffer_load_dwordx4 v18, s[8:11], s39 offen sc1 lds
s_add_u32 m0, s41, 3072
s_nop 0
buffer_load_dwordx4 v19, s[8:11], s39 offen sc1 lds
s_add_u32 m0, s40, 0
s_nop 0
buffer_load_dwordx4 v8, s[4:7], s38 offen sc1 lds
s_add_u32 m0, s40, 1024
s_nop 0
buffer_load_dwordx4 v9, s[4:7], s38 offen sc1 lds
s_add_u32 m0, s40, 2048
s_nop 0
buffer_load_dwordx4 v10, s[4:7], s38 offen sc1 lds
s_add_u32 m0, s40, 3072
s_nop 0
buffer_load_dwordx4 v11, s[4:7], s38 offen sc1 lds
s_add_u32 m0, s40, 4096
s_nop 0
buffer_load_dwordx4 v12, s[4:7], s38 offen sc1 lds
s_add_u32 m0, s40, 5120
s_nop 0
buffer_load_dwordx4 v13, s[4:7], s38 offen sc1 lds
s_add_u32 m0, s40, 6144
s_nop 0
buffer_load_dwordx4 v14, s[4:7], s38 offen sc1 lds
s_add_u32 m0, s40, 7168
s_nop 0
buffer_load_dwordx4 v15, s[4:7], s38 offen sc1 lds
s_add_u32 s34, s34, 1
s_add_u32 s35, s35, 1
s_cmp_eq_u32 s35, 3
s_cselect_b32 s35, 0, s35
s_waitcnt vmcnt(14)
s_waitcnt vmcnt(12)
v_cmp_ne_u64 vcc, s[66:67], v[26:27]
s_nop 4
s_cmp_eq_u64 vcc, 0
s_cbranch_scc1 pd_23
s_mov_b32 s19, 32768
pl_22:
buffer_load_dwordx2 v[26:27], v24, s[24:27], s29 offen sc1
s_waitcnt vmcnt(0)
v_cmp_ne_u64 vcc, s[66:67], v[26:27]
s_nop 4
s_cmp_eq_u64 vcc, 0
s_cbranch_scc1 pd_23
s_add_u32 s100, s100, 1
s_sleep 2
s_sub_u32 s19, s19, 1
s_cmp_lg_u32 s19, 0
s_cbranch_scc1 pl_22
pd_23:
v_cmp_ne_u64 vcc, s[66:67], v[34:35]
s_nop 4
s_cmp_eq_u64 vcc, 0
s_cbranch_scc1 pd_25
s_mov_b32 s19, 32768
pl_24:
buffer_load_dwordx2 v[34:35], v32, s[24:27], s31 offen sc1
s_waitcnt vmcnt(0)
v_cmp_ne_u64 vcc, s[66:67], v[34:35]
s_nop 4
s_cmp_eq_u64 vcc, 0
s_cbranch_scc1 pd_25
s_add_u32 s100, s100, 1
s_sleep 2
s_sub_u32 s19, s19, 1
s_cmp_lg_u32 s19, 0
s_cbranch_scc1 pl_24
pd_25:
s_barrier
p2_pm_26:
s_xor_b32 s36, s34, s47
s_add_u32 s36, s36, s22
s_and_b32 s36, s36, 7
s_and_b32 s37, s34, 8
s_xor_b32 s37, s37, s23
s_or_b32 s36, s36, s37
s_mul_i32 s39, s36, 16384
s_mul_i32 s41, s35, 16384
s_add_u32 s41, s41, s33
s_mul_i32 s38, s36, 32768
s_mul_i32 s40, s35, 32768
s_add_u32 s40, s40, s32
s_sub_u32 s37, s40, 163840
s_cmp_ge_u32 s40, 163840
s_cselect_b32 s40, s37, s40
s_add_u32 m0, s41, 0
s_nop 0
buffer_load_dwordx4 v16, s[8:11], s39 offen sc1 lds
s_add_u32 m0, s41, 1024
s_nop 0
buffer_load_dwordx4 v17, s[8:11], s39 offen sc1 lds
s_add_u32 m0, s41, 2048
s_nop 0
buffer_load_dwordx4 v18, s[8:11], s39 offen sc1 lds
s_add_u32 m0, s41, 3072
s_nop 0
buffer_load_dwordx4 v19, s[8:11], s39 offen sc1 lds
s_add_u32 m0, s40, 0
s_nop 0
buffer_load_dwordx4 v8, s[4:7], s38 offen sc1 lds
s_add_u32 m0, s40, 1024
s_nop 0
buffer_load_dwordx4 v9, s[4:7], s38 offen sc1 lds
s_add_u32 m0, s40, 2048
s_nop 0
buffer_load_dwordx4 v10, s[4:7], s38 offen sc1 lds
s_add_u32 m0, s40, 3072
s_nop 0
buffer_load_dwordx4 v11, s[4:7], s38 offen sc1 lds
s_add_u32 m0, s40, 4096
s_nop 0
buffer_load_dwordx4 v12, s[4:7], s38 offen sc1 lds
s_add_u32 m0, s40, 5120
s_nop 0
buffer_load_dwordx4 v13, s[4:7], s38 offen sc1 lds
s_add_u32 m0, s40, 6144
s_nop 0
buffer_load_dwordx4 v14, s[4:7], s38 offen sc1 lds
s_add_u32 m0, s40, 7168
s_nop 0
buffer_load_dwordx4 v15, s[4:7], s38 offen sc1 lds
s_add_u32 s34, s34, 1
s_add_u32 s35, s35, 1
s_cmp_eq_u32 s35, 3
s_cselect_b32 s35, 0, s35
s_waitcnt vmcnt(12)
s_barrier
s_cmp_lt_u32 s34, 16
s_cbranch_scc1 p2_pm_26
s_waitcnt vmcnt(0)
s_barrier
s_barrier
s_barrier
s_endpgm
L_gc:
v_and_b32 v250, 63, v0
s_bfe_u32 s17, s16, 0x10001
s_and_b32 s18, s16, 1
s_setprio 2
s_mul_i32 s19, s17, 8192
v_and_b32 v65, 15, v250
v_lshl_add_u32 v70, v65, 6, s19
v_lshrrev_b32 v65, 2, v65
v_sub_u32 v65, 0, v65
v_lshrrev_b32 v66, 4, v250
v_xor_b32 v65, v65, v66
v_and_b32 v65, 3, v65
v_lshl_add_u32 v70, v65, 4, v70
v_add_u32 v128, 0, v70
v_lshrrev_b32 v65, 4, v250
v_bfe_u32 v66, v250, 2, 2
v_and_b32 v67, 3, v250
v_lshl_add_u32 v68, v65, 2, v66
v_mul_u32_u24 v68, 256, v68
v_and_b32 v69, 1, v65
v_lshl_add_u32 v69, v69, 2, v66
v_lshlrev_b32 v69, 1, v69
v_lshl_add_u32 v68, v67, 3, v68
s_mul_i32 s19, s18, 8
s_add_u32 s36, s19, 0
v_xor_b32 v70, s36, v69
v_lshl_add_u32 v70, v70, 4, v68
v_add_u32 v129, 65536, v70
s_add_u32 s36, s19, 2
v_xor_b32 v70, s36, v69
v_lshl_add_u32 v70, v70, 4, v68
v_add_u32 v130, 65536, v70
s_add_u32 s36, s19, 4
v_xor_b32 v70, s36, v69
v_lshl_add_u32 v70, v70, 4, v68
v_add_u32 v131, 65536, v70
s_add_u32 s36, s19, 6
v_xor_b32 v70, s36, v69
v_lshl_add_u32 v70, v70, 4, v68
v_add_u32 v132, 65536, v70
v_mov_b64 v[0:1], 0
v_mov_b64 v[2:3], 0
v_mov_b64 v[4:5], 0
v_mov_b64 v[6:7], 0
v_mov_b64 v[8:9], 0
v_mov_b64 v[10:11], 0
v_mov_b64 v[12:13], 0
v_mov_b64 v[14:15], 0
v_mov_b64 v[16:17], 0
v_mov_b64 v[18:19], 0
v_mov_b64 v[20:21], 0
v_mov_b64 v[22:23], 0
v_mov_b64 v[24:25], 0
v_mov_b64 v[26:27], 0
v_mov_b64 v[28:29], 0
v_mov_b64 v[30:31], 0
v_mov_b64 v[32:33], 0
v_mov_b64 v[34:35], 0
v_mov_b64 v[36:37], 0
v_mov_b64 v[38:39], 0
v_mov_b64 v[40:41], 0
v_mov_b64 v[42:43], 0
v_mov_b64 v[44:45], 0
v_mov_b64 v[46:47], 0
v_mov_b64 v[48:49], 0
v_mov_b64 v[50:51], 0
v_mov_b64 v[52:53], 0
v_mov_b64 v[54:55], 0
v_mov_b64 v[56:57], 0
v_mov_b64 v[58:59], 0
v_mov_b64 v[60:61], 0
v_mov_b64 v[62:63], 0
s_barrier
s_waitcnt lgkmcnt(0)
s_barrier
ds_read_b128 v[64:67], v128 offset:0
ds_read_b64_tr_b16 v[80:81], v129 offset:0
ds_read_b64_tr_b16 v[82:83], v129 offset:8192
ds_read_b64_tr_b16 v[84:85], v130 offset:0
ds_read_b64_tr_b16 v[86:87], v130 offset:8192
ds_read_b64_tr_b16 v[88:89], v131 offset:0
ds_read_b64_tr_b16 v[90:91], v131 offset:8192
ds_read_b64_tr_b16 v[92:93], v132 offset:0
ds_read_b64_tr_b16 v[94:95], v132 offset:8192
ds_read_b128 v[68:71], v128 offset:2048
ds_read_b128 v[72:75], v128 offset:4096
ds_read_b128 v[76:79], v128 offset:6144
s_mov_b32 s19, 14
.p2align 6
p1_c0:
s_waitcnt lgkmcnt(9)
v_mfma_f32_16x16x32_bf16 v[0:3], v[64:67], v[80:83], v[0:3]
ds_read_b128 v[96:99], v128 offset:1024
s_waitcnt lgkmcnt(8)
v_mfma_f32_16x16x32_bf16 v[4:7], v[64:67], v[84:87], v[4:7]
ds_read_b64_tr_b16 v[112:113], v129 offset:4096
s_waitcnt lgkmcnt(7)
v_mfma_f32_16x16x32_bf16 v[8:11], v[64:67], v[88:91], v[8:11]
ds_read_b64_tr_b16 v[114:115], v129 offset:12288
s_waitcnt lgkmcnt(6)
v_mfma_f32_16x16x32_bf16 v[12:15], v[64:67], v[92:95], v[12:15]
ds_read_b64_tr_b16 v[116:117], v130 offset:4096
s_waitcnt lgkmcnt(6)
v_mfma_f32_16x16x32_bf16 v[28:31], v[68:71], v[92:95], v[28:31]
ds_read_b64_tr_b16 v[118:119], v130 offset:12288
v_mfma_f32_16x16x32_bf16 v[24:27], v[68:71], v[88:91], v[24:27]
ds_read_b64_tr_b16 v[120:121], v131 offset:4096
v_mfma_f32_16x16x32_bf16 v[20:23], v[68:71], v[84:87], v[20:23]
ds_read_b64_tr_b16 v[122:123], v131 offset:12288
v_mfma_f32_16x16x32_bf16 v[16:19], v[68:71], v[80:83], v[16:19]
ds_read_b64_tr_b16 v[124:125], v132 offset:4096
s_waitcnt lgkmcnt(9)
v_mfma_f32_16x16x32_bf16 v[32:35], v[72:75], v[80:83], v[32:35]
ds_read_b64_tr_b16 v[126:127], v132 offset:12288
v_mfma_f32_16x16x32_bf16 v[36:39], v[72:75], v[84:87], v[36:39]
ds_read_b128 v[100:103], v128 offset:3072
v_mfma_f32_16x16x32_bf16 v[40:43], v[72:75], v[88:91], v[40:43]
ds_read_b128 v[104:107], v128 offset:5120
v_mfma_f32_16x16x32_bf16 v[44:47], v[72:75], v[92:95], v[44:47]
ds_read_b128 v[108:111], v128 offset:7168
s_waitcnt lgkmcnt(12)
v_mfma_f32_16x16x32_bf16 v[60:63], v[76:79], v[92:95], v[60:63]
v_mfma_f32_16x16x32_bf16 v[56:59], v[76:79], v[88:91], v[56:59]
v_mfma_f32_16x16x32_bf16 v[52:55], v[76:79], v[84:87], v[52:55]
v_mfma_f32_16x16x32_bf16 v[48:51], v[76:79], v[80:83], v[48:51]
s_waitcnt lgkmcnt(0)
s_barrier
v_mfma_f32_16x16x32_bf16 v[0:3], v[96:99], v[112:115], v[0:3]
ds_read_b128 v[64:67], v128 offset:16384
v_mfma_f32_16x16x32_bf16 v[4:7], v[96:99], v[116:119], v[4:7]
ds_read_b64_tr_b16 v[80:81], v129 offset:16384
v_mfma_f32_16x16x32_bf16 v[8:11], v[96:99], v[120:123], v[8:11]
ds_read_b64_tr_b16 v[82:83], v129 offset:24576
v_mfma_f32_16x16x32_bf16 v[12:15], v[96:99], v[124:127], v[12:15]
ds_read_b64_tr_b16 v[84:85], v130 offset:16384
v_mfma_f32_16x16x32_bf16 v[28:31], v[100:103], v[124:127], v[28:31]
ds_read_b64_tr_b16 v[86:87], v130 offset:24576
v_mfma_f32_16x16x32_bf16 v[24:27], v[100:103], v[120:123], v[24:27]
ds_read_b64_tr_b16 v[88:89], v131 offset:16384
v_mfma_f32_16x16x32_bf16 v[20:23], v[100:103], v[116:119], v[20:23]
ds_read_b64_tr_b16 v[90:91], v131 offset:24576
v_mfma_f32_16x16x32_bf16 v[16:19], v[100:103], v[112:115], v[16:19]
ds_read_b64_tr_b16 v[92:93], v132 offset:16384
v_mfma_f32_16x16x32_bf16 v[32:35], v[104:107], v[112:115], v[32:35]
ds_read_b64_tr_b16 v[94:95], v132 offset:24576
v_mfma_f32_16x16x32_bf16 v[36:39], v[104:107], v[116:119], v[36:39]
ds_read_b128 v[68:71], v128 offset:18432
v_mfma_f32_16x16x32_bf16 v[40:43], v[104:107], v[120:123], v[40:43]
ds_read_b128 v[72:75], v128 offset:20480
v_mfma_f32_16x16x32_bf16 v[44:47], v[104:107], v[124:127], v[44:47]
ds_read_b128 v[76:79], v128 offset:22528
v_mfma_f32_16x16x32_bf16 v[60:63], v[108:111], v[124:127], v[60:63]
v_mfma_f32_16x16x32_bf16 v[56:59], v[108:111], v[120:123], v[56:59]
v_mfma_f32_16x16x32_bf16 v[52:55], v[108:111], v[116:119], v[52:55]
v_mfma_f32_16x16x32_bf16 v[48:51], v[108:111], v[112:115], v[48:51]
p1_c1:
s_waitcnt lgkmcnt(9)
v_mfma_f32_16x16x32_bf16 v[0:3], v[64:67], v[80:83], v[0:3]
ds_read_b128 v[96:99], v128 offset:17408
s_waitcnt lgkmcnt(8)
v_mfma_f32_16x16x32_bf16 v[4:7], v[64:67], v[84:87], v[4:7]
ds_read_b64_tr_b16 v[112:113], v129 offset:20480
s_waitcnt lgkmcnt(7)
v_mfma_f32_16x16x32_bf16 v[8:11], v[64:67], v[88:91], v[8:11]
ds_read_b64_tr_b16 v[114:115], v129 offset:28672
s_waitcnt lgkmcnt(6)
v_mfma_f32_16x16x32_bf16 v[12:15], v[64:67], v[92:95], v[12:15]
ds_read_b64_tr_b16 v[116:117], v130 offset:20480
s_waitcnt lgkmcnt(6)
v_mfma_f32_16x16x32_bf16 v[28:31], v[68:71], v[92:95], v[28:31]
ds_read_b64_tr_b16 v[118:119], v130 offset:28672
v_mfma_f32_16x16x32_bf16 v[24:27], v[68:71], v[88:91], v[24:27]
ds_read_b64_tr_b16 v[120:121], v131 offset:20480
v_mfma_f32_16x16x32_bf16 v[20:23], v[68:71], v[84:87], v[20:23]
ds_read_b64_tr_b16 v[122:123], v131 offset:28672
v_mfma_f32_16x16x32_bf16 v[16:19], v[68:71], v[80:83], v[16:19]
ds_read_b64_tr_b16 v[124:125], v132 offset:20480
s_waitcnt lgkmcnt(9)
v_mfma_f32_16x16x32_bf16 v[32:35], v[72:75], v[80:83], v[32:35]
ds_read_b64_tr_b16 v[126:127], v132 offset:28672
v_mfma_f32_16x16x32_bf16 v[36:39], v[72:75], v[84:87], v[36:39]
ds_read_b128 v[100:103], v128 offset:19456
v_mfma_f32_16x16x32_bf16 v[40:43], v[72:75], v[88:91], v[40:43]
ds_read_b128 v[104:107], v128 offset:21504
v_mfma_f32_16x16x32_bf16 v[44:47], v[72:75], v[92:95], v[44:47]
ds_read_b128 v[108:111], v128 offset:23552
s_waitcnt lgkmcnt(12)
v_mfma_f32_16x16x32_bf16 v[60:63], v[76:79], v[92:95], v[60:63]
v_mfma_f32_16x16x32_bf16 v[56:59], v[76:79], v[88:91], v[56:59]
v_mfma_f32_16x16x32_bf16 v[52:55], v[76:79], v[84:87], v[52:55]
v_mfma_f32_16x16x32_bf16 v[48:51], v[76:79], v[80:83], v[48:51]
s_waitcnt lgkmcnt(0)
s_barrier
v_mfma_f32_16x16x32_bf16 v[0:3], v[96:99], v[112:115], v[0:3]
ds_read_b128 v[64:67], v128 offset:32768
v_mfma_f32_16x16x32_bf16 v[4:7], v[96:99], v[116:119], v[4:7]
ds_read_b64_tr_b16 v[80:81], v129 offset:32768
v_mfma_f32_16x16x32_bf16 v[8:11], v[96:99], v[120:123], v[8:11]
ds_read_b64_tr_b16 v[82:83], v129 offset:40960
v_mfma_f32_16x16x32_bf16 v[12:15], v[96:99], v[124:127], v[12:15]
ds_read_b64_tr_b16 v[84:85], v130 offset:32768
v_mfma_f32_16x16x32_bf16 v[28:31], v[100:103], v[124:127], v[28:31]
ds_read_b64_tr_b16 v[86:87], v130 offset:40960
v_mfma_f32_16x16x32_bf16 v[24:27], v[100:103], v[120:123], v[24:27]
ds_read_b64_tr_b16 v[88:89], v131 offset:32768
v_mfma_f32_16x16x32_bf16 v[20:23], v[100:103], v[116:119], v[20:23]
ds_read_b64_tr_b16 v[90:91], v131 offset:40960
v_mfma_f32_16x16x32_bf16 v[16:19], v[100:103], v[112:115], v[16:19]
ds_read_b64_tr_b16 v[92:93], v132 offset:32768
v_mfma_f32_16x16x32_bf16 v[32:35], v[104:107], v[112:115], v[32:35]
ds_read_b64_tr_b16 v[94:95], v132 offset:40960
v_mfma_f32_16x16x32_bf16 v[36:39], v[104:107], v[116:119], v[36:39]
ds_read_b128 v[68:71], v128 offset:34816
v_mfma_f32_16x16x32_bf16 v[40:43], v[104:107], v[120:123], v[40:43]
ds_read_b128 v[72:75], v128 offset:36864
v_mfma_f32_16x16x32_bf16 v[44:47], v[104:107], v[124:127], v[44:47]
ds_read_b128 v[76:79], v128 offset:38912
v_mfma_f32_16x16x32_bf16 v[60:63], v[108:111], v[124:127], v[60:63]
v_mfma_f32_16x16x32_bf16 v[56:59], v[108:111], v[120:123], v[56:59]
v_mfma_f32_16x16x32_bf16 v[52:55], v[108:111], v[116:119], v[52:55]
v_mfma_f32_16x16x32_bf16 v[48:51], v[108:111], v[112:115], v[48:51]
p1_c2:
s_waitcnt lgkmcnt(9)
v_mfma_f32_16x16x32_bf16 v[0:3], v[64:67], v[80:83], v[0:3]
ds_read_b128 v[96:99], v128 offset:33792
s_waitcnt lgkmcnt(8)
v_mfma_f32_16x16x32_bf16 v[4:7], v[64:67], v[84:87], v[4:7]
ds_read_b64_tr_b16 v[112:113], v129 offset:36864
s_waitcnt lgkmcnt(7)
v_mfma_f32_16x16x32_bf16 v[8:11], v[64:67], v[88:91], v[8:11]
ds_read_b64_tr_b16 v[114:115], v129 offset:45056
s_waitcnt lgkmcnt(6)
v_mfma_f32_16x16x32_bf16 v[12:15], v[64:67], v[92:95], v[12:15]
ds_read_b64_tr_b16 v[116:117], v130 offset:36864
s_waitcnt lgkmcnt(6)
v_mfma_f32_16x16x32_bf16 v[28:31], v[68:71], v[92:95], v[28:31]
ds_read_b64_tr_b16 v[118:119], v130 offset:45056
v_mfma_f32_16x16x32_bf16 v[24:27], v[68:71], v[88:91], v[24:27]
ds_read_b64_tr_b16 v[120:121], v131 offset:36864
v_mfma_f32_16x16x32_bf16 v[20:23], v[68:71], v[84:87], v[20:23]
ds_read_b64_tr_b16 v[122:123], v131 offset:45056
v_mfma_f32_16x16x32_bf16 v[16:19], v[68:71], v[80:83], v[16:19]
ds_read_b64_tr_b16 v[124:125], v132 offset:36864
s_waitcnt lgkmcnt(9)
v_mfma_f32_16x16x32_bf16 v[32:35], v[72:75], v[80:83], v[32:35]
ds_read_b64_tr_b16 v[126:127], v132 offset:45056
v_mfma_f32_16x16x32_bf16 v[36:39], v[72:75], v[84:87], v[36:39]
ds_read_b128 v[100:103], v128 offset:35840
v_mfma_f32_16x16x32_bf16 v[40:43], v[72:75], v[88:91], v[40:43]
ds_read_b128 v[104:107], v128 offset:37888
v_mfma_f32_16x16x32_bf16 v[44:47], v[72:75], v[92:95], v[44:47]
ds_read_b128 v[108:111], v128 offset:39936
s_waitcnt lgkmcnt(12)
v_mfma_f32_16x16x32_bf16 v[60:63], v[76:79], v[92:95], v[60:63]
v_mfma_f32_16x16x32_bf16 v[56:59], v[76:79], v[88:91], v[56:59]
v_mfma_f32_16x16x32_bf16 v[52:55], v[76:79], v[84:87], v[52:55]
v_mfma_f32_16x16x32_bf16 v[48:51], v[76:79], v[80:83], v[48:51]
s_waitcnt lgkmcnt(0)
s_barrier
v_mfma_f32_16x16x32_bf16 v[0:3], v[96:99], v[112:115], v[0:3]
ds_read_b128 v[64:67], v128 offset:49152
v_mfma_f32_16x16x32_bf16 v[4:7], v[96:99], v[116:119], v[4:7]
ds_read_b64_tr_b16 v[80:81], v129 offset:49152
v_mfma_f32_16x16x32_bf16 v[8:11], v[96:99], v[120:123], v[8:11]
ds_read_b64_tr_b16 v[82:83], v129 offset:57344
v_mfma_f32_16x16x32_bf16 v[12:15], v[96:99], v[124:127], v[12:15]
ds_read_b64_tr_b16 v[84:85], v130 offset:49152
v_mfma_f32_16x16x32_bf16 v[28:31], v[100:103], v[124:127], v[28:31]
ds_read_b64_tr_b16 v[86:87], v130 offset:57344
v_mfma_f32_16x16x32_bf16 v[24:27], v[100:103], v[120:123], v[24:27]
ds_read_b64_tr_b16 v[88:89], v131 offset:49152
v_mfma_f32_16x16x32_bf16 v[20:23], v[100:103], v[116:119], v[20:23]
ds_read_b64_tr_b16 v[90:91], v131 offset:57344
v_mfma_f32_16x16x32_bf16 v[16:19], v[100:103], v[112:115], v[16:19]
ds_read_b64_tr_b16 v[92:93], v132 offset:49152
v_mfma_f32_16x16x32_bf16 v[32:35], v[104:107], v[112:115], v[32:35]
ds_read_b64_tr_b16 v[94:95], v132 offset:57344
v_mfma_f32_16x16x32_bf16 v[36:39], v[104:107], v[116:119], v[36:39]
ds_read_b128 v[68:71], v128 offset:51200
v_mfma_f32_16x16x32_bf16 v[40:43], v[104:107], v[120:123], v[40:43]
ds_read_b128 v[72:75], v128 offset:53248
v_mfma_f32_16x16x32_bf16 v[44:47], v[104:107], v[124:127], v[44:47]
ds_read_b128 v[76:79], v128 offset:55296
v_mfma_f32_16x16x32_bf16 v[60:63], v[108:111], v[124:127], v[60:63]
v_mfma_f32_16x16x32_bf16 v[56:59], v[108:111], v[120:123], v[56:59]
v_mfma_f32_16x16x32_bf16 v[52:55], v[108:111], v[116:119], v[52:55]
v_mfma_f32_16x16x32_bf16 v[48:51], v[108:111], v[112:115], v[48:51]
p1_c3:
s_waitcnt lgkmcnt(9)
v_mfma_f32_16x16x32_bf16 v[0:3], v[64:67], v[80:83], v[0:3]
ds_read_b128 v[96:99], v128 offset:50176
s_waitcnt lgkmcnt(8)
v_mfma_f32_16x16x32_bf16 v[4:7], v[64:67], v[84:87], v[4:7]
ds_read_b64_tr_b16 v[112:113], v129 offset:53248
s_waitcnt lgkmcnt(7)
v_mfma_f32_16x16x32_bf16 v[8:11], v[64:67], v[88:91], v[8:11]
ds_read_b64_tr_b16 v[114:115], v129 offset:61440
s_waitcnt lgkmcnt(6)
v_mfma_f32_16x16x32_bf16 v[12:15], v[64:67], v[92:95], v[12:15]
ds_read_b64_tr_b16 v[116:117], v130 offset:53248
s_waitcnt lgkmcnt(6)
v_mfma_f32_16x16x32_bf16 v[28:31], v[68:71], v[92:95], v[28:31]
ds_read_b64_tr_b16 v[118:119], v130 offset:61440
v_mfma_f32_16x16x32_bf16 v[24:27], v[68:71], v[88:91], v[24:27]
ds_read_b64_tr_b16 v[120:121], v131 offset:53248
v_mfma_f32_16x16x32_bf16 v[20:23], v[68:71], v[84:87], v[20:23]
ds_read_b64_tr_b16 v[122:123], v131 offset:61440
v_mfma_f32_16x16x32_bf16 v[16:19], v[68:71], v[80:83], v[16:19]
ds_read_b64_tr_b16 v[124:125], v132 offset:53248
s_waitcnt lgkmcnt(9)
v_mfma_f32_16x16x32_bf16 v[32:35], v[72:75], v[80:83], v[32:35]
ds_read_b64_tr_b16 v[126:127], v132 offset:61440
v_mfma_f32_16x16x32_bf16 v[36:39], v[72:75], v[84:87], v[36:39]
ds_read_b128 v[100:103], v128 offset:52224
v_mfma_f32_16x16x32_bf16 v[40:43], v[72:75], v[88:91], v[40:43]
ds_read_b128 v[104:107], v128 offset:54272
v_mfma_f32_16x16x32_bf16 v[44:47], v[72:75], v[92:95], v[44:47]
ds_read_b128 v[108:111], v128 offset:56320
s_waitcnt lgkmcnt(12)
v_mfma_f32_16x16x32_bf16 v[60:63], v[76:79], v[92:95], v[60:63]
v_mfma_f32_16x16x32_bf16 v[56:59], v[76:79], v[88:91], v[56:59]
v_mfma_f32_16x16x32_bf16 v[52:55], v[76:79], v[84:87], v[52:55]
v_mfma_f32_16x16x32_bf16 v[48:51], v[76:79], v[80:83], v[48:51]
s_waitcnt lgkmcnt(0)
s_barrier
v_mfma_f32_16x16x32_bf16 v[0:3], v[96:99], v[112:115], v[0:3]
ds_read_b128 v[64:67], v128 offset:0
v_mfma_f32_16x16x32_bf16 v[4:7], v[96:99], v[116:119], v[4:7]
ds_read_b64_tr_b16 v[80:81], v129 offset:0
v_mfma_f32_16x16x32_bf16 v[8:11], v[96:99], v[120:123], v[8:11]
ds_read_b64_tr_b16 v[82:83], v129 offset:8192
v_mfma_f32_16x16x32_bf16 v[12:15], v[96:99], v[124:127], v[12:15]
ds_read_b64_tr_b16 v[84:85], v130 offset:0
v_mfma_f32_16x16x32_bf16 v[28:31], v[100:103], v[124:127], v[28:31]
ds_read_b64_tr_b16 v[86:87], v130 offset:8192
v_mfma_f32_16x16x32_bf16 v[24:27], v[100:103], v[120:123], v[24:27]
ds_read_b64_tr_b16 v[88:89], v131 offset:0
v_mfma_f32_16x16x32_bf16 v[20:23], v[100:103], v[116:119], v[20:23]
ds_read_b64_tr_b16 v[90:91], v131 offset:8192
v_mfma_f32_16x16x32_bf16 v[16:19], v[100:103], v[112:115], v[16:19]
ds_read_b64_tr_b16 v[92:93], v132 offset:0
v_mfma_f32_16x16x32_bf16 v[32:35], v[104:107], v[112:115], v[32:35]
ds_read_b64_tr_b16 v[94:95], v132 offset:8192
v_mfma_f32_16x16x32_bf16 v[36:39], v[104:107], v[116:119], v[36:39]
ds_read_b128 v[68:71], v128 offset:2048
v_mfma_f32_16x16x32_bf16 v[40:43], v[104:107], v[120:123], v[40:43]
ds_read_b128 v[72:75], v128 offset:4096
v_mfma_f32_16x16x32_bf16 v[44:47], v[104:107], v[124:127], v[44:47]
ds_read_b128 v[76:79], v128 offset:6144
v_mfma_f32_16x16x32_bf16 v[60:63], v[108:111], v[124:127], v[60:63]
v_mfma_f32_16x16x32_bf16 v[56:59], v[108:111], v[120:123], v[56:59]
v_mfma_f32_16x16x32_bf16 v[52:55], v[108:111], v[116:119], v[52:55]
s_sub_u32 s19, s19, 1
s_cmp_lg_u32 s19, 0
v_mfma_f32_16x16x32_bf16 v[48:51], v[108:111], v[112:115], v[48:51]
s_cbranch_scc1 p1_c0
s_waitcnt lgkmcnt(0)
s_barrier
s_nop 7
s_lshl_b32 s36, s45, 4
s_lshl_b32 s37, s44, 1
s_add_u32 s36, s36, s37
s_add_u32 s36, s36, s17
s_lshl_b32 s36, s36, 14
s_lshl_b32 s37, s18, 13
s_add_u32 s36, s36, s37
s_bfe_u32 s39, s43, 65538
s_xor_b32 s39, s39, s17
s_lshl_b32 s39, s39, 14
s_add_u32 s39, s39, s37
s_add_u32 s39, s39, 65536
s_add_u32 s37, s36, 4096
s_lshl_b32 s38, s18, 2
v_xor_b32 v112, s38, v250
v_xor_b32 v104, 0, v112
v_lshlrev_b32 v104, 4, v104
v_add_u32 v108, s39, v104
v_xor_b32 v105, 1, v112
v_lshlrev_b32 v105, 4, v105
v_add_u32 v109, s39, v105
v_xor_b32 v106, 2, v112
v_lshlrev_b32 v106, 4, v106
v_add_u32 v110, s39, v106
v_xor_b32 v107, 3, v112
v_lshlrev_b32 v107, 4, v107
v_add_u32 v111, s39, v107
v_cvt_pk_bf16_f32 v64, v0, v1
v_cvt_pk_bf16_f32 v65, v2, v3
v_cvt_pk_bf16_f32 v66, v16, v17
v_cvt_pk_bf16_f32 v67, v18, v19
buffer_store_dwordx4 v[64:67], v104, s[12:15], s36 offen offset:0 sc1
v_cvt_pk_bf16_f32 v68, v32, v33
v_cvt_pk_bf16_f32 v69, v34, v35
v_cvt_pk_bf16_f32 v70, v48, v49
v_cvt_pk_bf16_f32 v71, v50, v51
buffer_store_dwordx4 v[68:71], v104, s[12:15], s36 offen offset:1024 sc1
v_cvt_pk_bf16_f32 v72, v4, v5
v_cvt_pk_bf16_f32 v73, v6, v7
v_cvt_pk_bf16_f32 v74, v20, v21
v_cvt_pk_bf16_f32 v75, v22, v23
buffer_store_dwordx4 v[72:75], v105, s[12:15], s36 offen offset:2048 sc1
v_cvt_pk_bf16_f32 v76, v36, v37
v_cvt_pk_bf16_f32 v77, v38, v39
v_cvt_pk_bf16_f32 v78, v52, v53
v_cvt_pk_bf16_f32 v79, v54, v55
buffer_store_dwordx4 v[76:79], v105, s[12:15], s36 offen offset:3072 sc1
v_cvt_pk_bf16_f32 v80, v8, v9
v_cvt_pk_bf16_f32 v81, v10, v11
v_cvt_pk_bf16_f32 v82, v24, v25
v_cvt_pk_bf16_f32 v83, v26, v27
buffer_store_dwordx4 v[80:83], v106, s[12:15], s37 offen offset:0 sc1
v_cvt_pk_bf16_f32 v84, v40, v41
v_cvt_pk_bf16_f32 v85, v42, v43
v_cvt_pk_bf16_f32 v86, v56, v57
v_cvt_pk_bf16_f32 v87, v58, v59
buffer_store_dwordx4 v[84:87], v106, s[12:15], s37 offen offset:1024 sc1
v_cvt_pk_bf16_f32 v88, v12, v13
v_cvt_pk_bf16_f32 v89, v14, v15
v_cvt_pk_bf16_f32 v90, v28, v29
v_cvt_pk_bf16_f32 v91, v30, v31
buffer_store_dwordx4 v[88:91], v107, s[12:15], s37 offen offset:2048 sc1
v_cvt_pk_bf16_f32 v92, v44, v45
v_cvt_pk_bf16_f32 v93, v46, v47
v_cvt_pk_bf16_f32 v94, v60, v61
v_cvt_pk_bf16_f32 v95, v62, v63
buffer_store_dwordx4 v[92:95], v107, s[12:15], s37 offen offset:3072 sc1
ds_write_b128 v108, v[64:67] offset:0
ds_write_b128 v108, v[68:71] offset:1024
ds_write_b128 v109, v[72:75] offset:2048
ds_write_b128 v109, v[76:79] offset:3072
ds_write_b128 v110, v[80:83] offset:4096
ds_write_b128 v110, v[84:87] offset:5120
ds_write_b128 v111, v[88:91] offset:6144
ds_write_b128 v111, v[92:95] offset:7168
s_and_b32 s22, s44, 3
s_lshl_b32 s22, s22, 1
s_lshr_b32 s23, s44, 2
s_lshl_b32 s23, s23, 3
s_lshl_b32 s21, s45, 18
s_lshl_b32 s20, s44, 19
s_bfe_u32 s47, s43, 0x10002
s_add_u32 s4, s64, 16777216
s_addc_u32 s5, s65, 0
s_mov_b32 s6, 4194304
s_mov_b32 s7, 0x20000
s_add_u32 s8, s64, 8388608
s_addc_u32 s9, s65, 0
s_mov_b32 s10, 7340032
s_mov_b32 s11, 0x20000
s_mov_b32 s12, s60
s_mov_b32 s13, s61
s_mov_b32 s14, 14680064
s_mov_b32 s15, 0x20000
s_and_b32 s17, s16, 3
s_mov_b32 s18, 0
s_waitcnt lgkmcnt(0)
s_mul_i32 s19, s17, 8192
v_lshl_add_u32 v134, v250, 4, s19
v_add_u32 v224, 0, v134
v_add_u32 v225, 131072, v134
v_bfe_u32 v129, v250, 1, 3
v_lshlrev_b32 v130, 11, v129
v_add_u32 v130, 65536, v130
v_lshrrev_b32 v131, 4, v250
v_lshl_add_u32 v130, v131, 8, v130
v_and_b32 v131, 1, v250
v_lshl_add_u32 v130, v131, 7, v130
v_xor_b32 v131, 0, v129
v_lshl_add_u32 v226, v131, 4, v130
v_xor_b32 v131, 1, v129
v_lshl_add_u32 v227, v131, 4, v130
v_xor_b32 v131, 2, v129
v_lshl_add_u32 v228, v131, 4, v130
v_xor_b32 v131, 3, v129
v_lshl_add_u32 v229, v131, 4, v130
v_xor_b32 v131, 4, v129
v_lshl_add_u32 v230, v131, 4, v130
v_xor_b32 v131, 5, v129
v_lshl_add_u32 v231, v131, 4, v130
v_xor_b32 v131, 6, v129
v_lshl_add_u32 v232, v131, 4, v130
v_xor_b32 v131, 7, v129
v_lshl_add_u32 v233, v131, 4, v130
v_mov_b64 v[0:1], 0
v_mov_b64 v[2:3], 0
v_mov_b64 v[4:5], 0
v_mov_b64 v[6:7], 0
v_mov_b64 v[8:9], 0
v_mov_b64 v[10:11], 0
v_mov_b64 v[12:13], 0
v_mov_b64 v[14:15], 0
v_mov_b64 v[16:17], 0
v_mov_b64 v[18:19], 0
v_mov_b64 v[20:21], 0
v_mov_b64 v[22:23], 0
v_mov_b64 v[24:25], 0
v_mov_b64 v[26:27], 0
v_mov_b64 v[28:29], 0
v_mov_b64 v[30:31], 0
v_mov_b64 v[32:33], 0
v_mov_b64 v[34:35], 0
v_mov_b64 v[36:37], 0
v_mov_b64 v[38:39], 0
v_mov_b64 v[40:41], 0
v_mov_b64 v[42:43], 0
v_mov_b64 v[44:45], 0
v_mov_b64 v[46:47], 0
v_mov_b64 v[48:49], 0
v_mov_b64 v[50:51], 0
v_mov_b64 v[52:53], 0
v_mov_b64 v[54:55], 0
v_mov_b64 v[56:57], 0
v_mov_b64 v[58:59], 0
v_mov_b64 v[60:61], 0
v_mov_b64 v[62:63], 0
v_mov_b64 v[64:65], 0
v_mov_b64 v[66:67], 0
v_mov_b64 v[68:69], 0
v_mov_b64 v[70:71], 0
v_mov_b64 v[72:73], 0
v_mov_b64 v[74:75], 0
v_mov_b64 v[76:77], 0
v_mov_b64 v[78:79], 0
v_mov_b64 v[80:81], 0
v_mov_b64 v[82:83], 0
v_mov_b64 v[84:85], 0
v_mov_b64 v[86:87], 0
v_mov_b64 v[88:89], 0
v_mov_b64 v[90:91], 0
v_mov_b64 v[92:93], 0
v_mov_b64 v[94:95], 0
v_mov_b64 v[96:97], 0
v_mov_b64 v[98:99], 0
v_mov_b64 v[100:101], 0
v_mov_b64 v[102:103], 0
v_mov_b64 v[104:105], 0
v_mov_b64 v[106:107], 0
v_mov_b64 v[108:109], 0
v_mov_b64 v[110:111], 0
v_mov_b64 v[112:113], 0
v_mov_b64 v[114:115], 0
v_mov_b64 v[116:117], 0
v_mov_b64 v[118:119], 0
v_mov_b64 v[120:121], 0
v_mov_b64 v[122:123], 0
v_mov_b64 v[124:125], 0
v_mov_b64 v[126:127], 0
s_waitcnt vmcnt(0) lgkmcnt(0)
s_barrier
ds_read_b128 v[128:131], v225 offset:0
ds_read_b128 v[144:147], v226 offset:0
ds_read_b128 v[132:135], v225 offset:2048
ds_read_b128 v[136:139], v225 offset:4096
ds_read_b128 v[140:143], v225 offset:6144
ds_read_b128 v[148:151], v227 offset:0
ds_read_b128 v[152:155], v228 offset:0
ds_read_b128 v[156:159], v229 offset:0
ds_read_b128 v[160:163], v230 offset:0
ds_read_b128 v[164:167], v231 offset:0
ds_read_b128 v[168:171], v232 offset:0
ds_read_b128 v[172:175], v233 offset:0
s_mov_b32 s19, 6
s_branch p2_c2
.p2align 6
p2_c0:
s_waitcnt lgkmcnt(10)
v_mfma_f32_16x16x32_bf16 v[0:3], v[128:131], v[144:147], v[0:3]
ds_read_b128 v[176:179], v224 offset:1024
s_waitcnt lgkmcnt(10)
v_mfma_f32_16x16x32_bf16 v[32:35], v[132:135], v[144:147], v[32:35]
ds_read_b128 v[192:195], v226 offset:17408
s_waitcnt lgkmcnt(10)
v_mfma_f32_16x16x32_bf16 v[64:67], v[136:139], v[144:147], v[64:67]
ds_read_b128 v[180:183], v224 offset:3072
s_waitcnt lgkmcnt(10)
v_mfma_f32_16x16x32_bf16 v[96:99], v[140:143], v[144:147], v[96:99]
ds_read_b128 v[184:187], v224 offset:5120
s_waitcnt lgkmcnt(10)
v_mfma_f32_16x16x32_bf16 v[100:103], v[140:143], v[148:151], v[100:103]
ds_read_b128 v[188:191], v224 offset:7168
v_mfma_f32_16x16x32_bf16 v[68:71], v[136:139], v[148:151], v[68:71]
ds_read_b128 v[196:199], v227 offset:17408
v_mfma_f32_16x16x32_bf16 v[36:39], v[132:135], v[148:151], v[36:39]
ds_read_b128 v[200:203], v228 offset:17408
v_mfma_f32_16x16x32_bf16 v[4:7], v[128:131], v[148:151], v[4:7]
ds_read_b128 v[204:207], v229 offset:17408
s_waitcnt lgkmcnt(13)
v_mfma_f32_16x16x32_bf16 v[8:11], v[128:131], v[152:155], v[8:11]
ds_read_b128 v[208:211], v230 offset:17408
v_mfma_f32_16x16x32_bf16 v[40:43], v[132:135], v[152:155], v[40:43]
ds_read_b128 v[212:215], v231 offset:17408
v_mfma_f32_16x16x32_bf16 v[72:75], v[136:139], v[152:155], v[72:75]
ds_read_b128 v[216:219], v232 offset:17408
v_mfma_f32_16x16x32_bf16 v[104:107], v[140:143], v[152:155], v[104:107]
ds_read_b128 v[220:223], v233 offset:17408
s_waitcnt lgkmcnt(15)
v_mfma_f32_16x16x32_bf16 v[108:111], v[140:143], v[156:159], v[108:111]
v_mfma_f32_16x16x32_bf16 v[76:79], v[136:139], v[156:159], v[76:79]
v_mfma_f32_16x16x32_bf16 v[44:47], v[132:135], v[156:159], v[44:47]
v_mfma_f32_16x16x32_bf16 v[12:15], v[128:131], v[156:159], v[12:15]
s_waitcnt lgkmcnt(15)
v_mfma_f32_16x16x32_bf16 v[16:19], v[128:131], v[160:163], v[16:19]
v_mfma_f32_16x16x32_bf16 v[48:51], v[132:135], v[160:163], v[48:51]
v_mfma_f32_16x16x32_bf16 v[80:83], v[136:139], v[160:163], v[80:83]
v_mfma_f32_16x16x32_bf16 v[112:115], v[140:143], v[160:163], v[112:115]
s_waitcnt lgkmcnt(14)
v_mfma_f32_16x16x32_bf16 v[116:119], v[140:143], v[164:167], v[116:119]
v_mfma_f32_16x16x32_bf16 v[84:87], v[136:139], v[164:167], v[84:87]
v_mfma_f32_16x16x32_bf16 v[52:55], v[132:135], v[164:167], v[52:55]
v_mfma_f32_16x16x32_bf16 v[20:23], v[128:131], v[164:167], v[20:23]
s_waitcnt lgkmcnt(13)
v_mfma_f32_16x16x32_bf16 v[24:27], v[128:131], v[168:171], v[24:27]
v_mfma_f32_16x16x32_bf16 v[56:59], v[132:135], v[168:171], v[56:59]
v_mfma_f32_16x16x32_bf16 v[88:91], v[136:139], v[168:171], v[88:91]
v_mfma_f32_16x16x32_bf16 v[120:123], v[140:143], v[168:171], v[120:123]
s_waitcnt lgkmcnt(12)
v_mfma_f32_16x16x32_bf16 v[124:127], v[140:143], v[172:175], v[124:127]
v_mfma_f32_16x16x32_bf16 v[92:95], v[136:139], v[172:175], v[92:95]
v_mfma_f32_16x16x32_bf16 v[60:63], v[132:135], v[172:175], v[60:63]
v_mfma_f32_16x16x32_bf16 v[28:31], v[128:131], v[172:175], v[28:31]
s_waitcnt lgkmcnt(0)
s_barrier
v_mfma_f32_16x16x32_bf16 v[0:3], v[176:179], v[192:195], v[0:3]
ds_read_b128 v[128:131], v224 offset:32768
v_mfma_f32_16x16x32_bf16 v[32:35], v[180:183], v[192:195], v[32:35]
ds_read_b128 v[144:147], v226 offset:32768
v_mfma_f32_16x16x32_bf16 v[64:67], v[184:187], v[192:195], v[64:67]
ds_read_b128 v[132:135], v224 offset:34816
v_mfma_f32_16x16x32_bf16 v[96:99], v[188:191], v[192:195], v[96:99]
ds_read_b128 v[136:139], v224 offset:36864
v_mfma_f32_16x16x32_bf16 v[100:103], v[188:191], v[196:199], v[100:103]
ds_read_b128 v[140:143], v224 offset:38912
v_mfma_f32_16x16x32_bf16 v[68:71], v[184:187], v[196:199], v[68:71]
ds_read_b128 v[148:151], v227 offset:32768
v_mfma_f32_16x16x32_bf16 v[36:39], v[180:183], v[196:199], v[36:39]
ds_read_b128 v[152:155], v228 offset:32768
v_mfma_f32_16x16x32_bf16 v[4:7], v[176:179], v[196:199], v[4:7]
ds_read_b128 v[156:159], v229 offset:32768
v_mfma_f32_16x16x32_bf16 v[8:11], v[176:179], v[200:203], v[8:11]
ds_read_b128 v[160:163], v230 offset:32768
v_mfma_f32_16x16x32_bf16 v[40:43], v[180:183], v[200:203], v[40:43]
ds_read_b128 v[164:167], v231 offset:32768
v_mfma_f32_16x16x32_bf16 v[72:75], v[184:187], v[200:203], v[72:75]
ds_read_b128 v[168:171], v232 offset:32768
v_mfma_f32_16x16x32_bf16 v[104:107], v[188:191], v[200:203], v[104:107]
ds_read_b128 v[172:175], v233 offset:32768
v_mfma_f32_16x16x32_bf16 v[108:111], v[188:191], v[204:207], v[108:111]
v_mfma_f32_16x16x32_bf16 v[76:79], v[184:187], v[204:207], v[76:79]
v_mfma_f32_16x16x32_bf16 v[44:47], v[180:183], v[204:207], v[44:47]
v_mfma_f32_16x16x32_bf16 v[12:15], v[176:179], v[204:207], v[12:15]
v_mfma_f32_16x16x32_bf16 v[16:19], v[176:179], v[208:211], v[16:19]
v_mfma_f32_16x16x32_bf16 v[48:51], v[180:183], v[208:211], v[48:51]
v_mfma_f32_16x16x32_bf16 v[80:83], v[184:187], v[208:211], v[80:83]
v_mfma_f32_16x16x32_bf16 v[112:115], v[188:191], v[208:211], v[112:115]
v_mfma_f32_16x16x32_bf16 v[116:119], v[188:191], v[212:215], v[116:119]
v_mfma_f32_16x16x32_bf16 v[84:87], v[184:187], v[212:215], v[84:87]
v_mfma_f32_16x16x32_bf16 v[52:55], v[180:183], v[212:215], v[52:55]
v_mfma_f32_16x16x32_bf16 v[20:23], v[176:179], v[212:215], v[20:23]
v_mfma_f32_16x16x32_bf16 v[24:27], v[176:179], v[216:219], v[24:27]
v_mfma_f32_16x16x32_bf16 v[56:59], v[180:183], v[216:219], v[56:59]
v_mfma_f32_16x16x32_bf16 v[88:91], v[184:187], v[216:219], v[88:91]
v_mfma_f32_16x16x32_bf16 v[120:123], v[188:191], v[216:219], v[120:123]
v_mfma_f32_16x16x32_bf16 v[124:127], v[188:191], v[220:223], v[124:127]
v_mfma_f32_16x16x32_bf16 v[92:95], v[184:187], v[220:223], v[92:95]
v_mfma_f32_16x16x32_bf16 v[60:63], v[180:183], v[220:223], v[60:63]
v_mfma_f32_16x16x32_bf16 v[28:31], v[176:179], v[220:223], v[28:31]
p2_c1:
s_waitcnt lgkmcnt(10)
v_mfma_f32_16x16x32_bf16 v[0:3], v[128:131], v[144:147], v[0:3]
ds_read_b128 v[176:179], v224 offset:33792
s_waitcnt lgkmcnt(10)
v_mfma_f32_16x16x32_bf16 v[32:35], v[132:135], v[144:147], v[32:35]
ds_read_b128 v[192:195], v226 offset:33792
s_waitcnt lgkmcnt(10)
v_mfma_f32_16x16x32_bf16 v[64:67], v[136:139], v[144:147], v[64:67]
ds_read_b128 v[180:183], v224 offset:35840
s_waitcnt lgkmcnt(10)
v_mfma_f32_16x16x32_bf16 v[96:99], v[140:143], v[144:147], v[96:99]
ds_read_b128 v[184:187], v224 offset:37888
s_waitcnt lgkmcnt(10)
v_mfma_f32_16x16x32_bf16 v[100:103], v[140:143], v[148:151], v[100:103]
ds_read_b128 v[188:191], v224 offset:39936
v_mfma_f32_16x16x32_bf16 v[68:71], v[136:139], v[148:151], v[68:71]
ds_read_b128 v[196:199], v227 offset:33792
v_mfma_f32_16x16x32_bf16 v[36:39], v[132:135], v[148:151], v[36:39]
ds_read_b128 v[200:203], v228 offset:33792
v_mfma_f32_16x16x32_bf16 v[4:7], v[128:131], v[148:151], v[4:7]
ds_read_b128 v[204:207], v229 offset:33792
s_waitcnt lgkmcnt(13)
v_mfma_f32_16x16x32_bf16 v[8:11], v[128:131], v[152:155], v[8:11]
ds_read_b128 v[208:211], v230 offset:33792
v_mfma_f32_16x16x32_bf16 v[40:43], v[132:135], v[152:155], v[40:43]
ds_read_b128 v[212:215], v231 offset:33792
v_mfma_f32_16x16x32_bf16 v[72:75], v[136:139], v[152:155], v[72:75]
ds_read_b128 v[216:219], v232 offset:33792
v_mfma_f32_16x16x32_bf16 v[104:107], v[140:143], v[152:155], v[104:107]
ds_read_b128 v[220:223], v233 offset:33792
s_waitcnt lgkmcnt(15)
v_mfma_f32_16x16x32_bf16 v[108:111], v[140:143], v[156:159], v[108:111]
v_mfma_f32_16x16x32_bf16 v[76:79], v[136:139], v[156:159], v[76:79]
v_mfma_f32_16x16x32_bf16 v[44:47], v[132:135], v[156:159], v[44:47]
v_mfma_f32_16x16x32_bf16 v[12:15], v[128:131], v[156:159], v[12:15]
s_waitcnt lgkmcnt(15)
v_mfma_f32_16x16x32_bf16 v[16:19], v[128:131], v[160:163], v[16:19]
v_mfma_f32_16x16x32_bf16 v[48:51], v[132:135], v[160:163], v[48:51]
v_mfma_f32_16x16x32_bf16 v[80:83], v[136:139], v[160:163], v[80:83]
v_mfma_f32_16x16x32_bf16 v[112:115], v[140:143], v[160:163], v[112:115]
s_waitcnt lgkmcnt(14)
v_mfma_f32_16x16x32_bf16 v[116:119], v[140:143], v[164:167], v[116:119]
v_mfma_f32_16x16x32_bf16 v[84:87], v[136:139], v[164:167], v[84:87]
v_mfma_f32_16x16x32_bf16 v[52:55], v[132:135], v[164:167], v[52:55]
v_mfma_f32_16x16x32_bf16 v[20:23], v[128:131], v[164:167], v[20:23]
s_waitcnt lgkmcnt(13)
v_mfma_f32_16x16x32_bf16 v[24:27], v[128:131], v[168:171], v[24:27]
v_mfma_f32_16x16x32_bf16 v[56:59], v[132:135], v[168:171], v[56:59]
v_mfma_f32_16x16x32_bf16 v[88:91], v[136:139], v[168:171], v[88:91]
v_mfma_f32_16x16x32_bf16 v[120:123], v[140:143], v[168:171], v[120:123]
s_waitcnt lgkmcnt(12)
v_mfma_f32_16x16x32_bf16 v[124:127], v[140:143], v[172:175], v[124:127]
v_mfma_f32_16x16x32_bf16 v[92:95], v[136:139], v[172:175], v[92:95]
v_mfma_f32_16x16x32_bf16 v[60:63], v[132:135], v[172:175], v[60:63]
v_mfma_f32_16x16x32_bf16 v[28:31], v[128:131], v[172:175], v[28:31]
s_waitcnt lgkmcnt(0)
s_barrier
v_mfma_f32_16x16x32_bf16 v[0:3], v[176:179], v[192:195], v[0:3]
ds_read_b128 v[128:131], v225 offset:0
v_mfma_f32_16x16x32_bf16 v[32:35], v[180:183], v[192:195], v[32:35]
ds_read_b128 v[144:147], v226 offset:0
v_mfma_f32_16x16x32_bf16 v[64:67], v[184:187], v[192:195], v[64:67]
ds_read_b128 v[132:135], v225 offset:2048
v_mfma_f32_16x16x32_bf16 v[96:99], v[188:191], v[192:195], v[96:99]
ds_read_b128 v[136:139], v225 offset:4096
v_mfma_f32_16x16x32_bf16 v[100:103], v[188:191], v[196:199], v[100:103]
ds_read_b128 v[140:143], v225 offset:6144
v_mfma_f32_16x16x32_bf16 v[68:71], v[184:187], v[196:199], v[68:71]
ds_read_b128 v[148:151], v227 offset:0
v_mfma_f32_16x16x32_bf16 v[36:39], v[180:183], v[196:199], v[36:39]
ds_read_b128 v[152:155], v228 offset:0
v_mfma_f32_16x16x32_bf16 v[4:7], v[176:179], v[196:199], v[4:7]
ds_read_b128 v[156:159], v229 offset:0
v_mfma_f32_16x16x32_bf16 v[8:11], v[176:179], v[200:203], v[8:11]
ds_read_b128 v[160:163], v230 offset:0
v_mfma_f32_16x16x32_bf16 v[40:43], v[180:183], v[200:203], v[40:43]
ds_read_b128 v[164:167], v231 offset:0
v_mfma_f32_16x16x32_bf16 v[72:75], v[184:187], v[200:203], v[72:75]
ds_read_b128 v[168:171], v232 offset:0
v_mfma_f32_16x16x32_bf16 v[104:107], v[188:191], v[200:203], v[104:107]
ds_read_b128 v[172:175], v233 offset:0
v_mfma_f32_16x16x32_bf16 v[108:111], v[188:191], v[204:207], v[108:111]
v_mfma_f32_16x16x32_bf16 v[76:79], v[184:187], v[204:207], v[76:79]
v_mfma_f32_16x16x32_bf16 v[44:47], v[180:183], v[204:207], v[44:47]
v_mfma_f32_16x16x32_bf16 v[12:15], v[176:179], v[204:207], v[12:15]
v_mfma_f32_16x16x32_bf16 v[16:19], v[176:179], v[208:211], v[16:19]
v_mfma_f32_16x16x32_bf16 v[48:51], v[180:183], v[208:211], v[48:51]
v_mfma_f32_16x16x32_bf16 v[80:83], v[184:187], v[208:211], v[80:83]
v_mfma_f32_16x16x32_bf16 v[112:115], v[188:191], v[208:211], v[112:115]
v_mfma_f32_16x16x32_bf16 v[116:119], v[188:191], v[212:215], v[116:119]
v_mfma_f32_16x16x32_bf16 v[84:87], v[184:187], v[212:215], v[84:87]
v_mfma_f32_16x16x32_bf16 v[52:55], v[180:183], v[212:215], v[52:55]
v_mfma_f32_16x16x32_bf16 v[20:23], v[176:179], v[212:215], v[20:23]
v_mfma_f32_16x16x32_bf16 v[24:27], v[176:179], v[216:219], v[24:27]
v_mfma_f32_16x16x32_bf16 v[56:59], v[180:183], v[216:219], v[56:59]
v_mfma_f32_16x16x32_bf16 v[88:91], v[184:187], v[216:219], v[88:91]
v_mfma_f32_16x16x32_bf16 v[120:123], v[188:191], v[216:219], v[120:123]
v_mfma_f32_16x16x32_bf16 v[124:127], v[188:191], v[220:223], v[124:127]
v_mfma_f32_16x16x32_bf16 v[92:95], v[184:187], v[220:223], v[92:95]
v_mfma_f32_16x16x32_bf16 v[60:63], v[180:183], v[220:223], v[60:63]
v_mfma_f32_16x16x32_bf16 v[28:31], v[176:179], v[220:223], v[28:31]
p2_c2:
s_waitcnt lgkmcnt(10)
v_mfma_f32_16x16x32_bf16 v[0:3], v[128:131], v[144:147], v[0:3]
ds_read_b128 v[176:179], v225 offset:1024
s_waitcnt lgkmcnt(10)
v_mfma_f32_16x16x32_bf16 v[32:35], v[132:135], v[144:147], v[32:35]
ds_read_b128 v[192:195], v226 offset:1024
s_waitcnt lgkmcnt(10)
v_mfma_f32_16x16x32_bf16 v[64:67], v[136:139], v[144:147], v[64:67]
ds_read_b128 v[180:183], v225 offset:3072
s_waitcnt lgkmcnt(10)
v_mfma_f32_16x16x32_bf16 v[96:99], v[140:143], v[144:147], v[96:99]
ds_read_b128 v[184:187], v225 offset:5120
s_waitcnt lgkmcnt(10)
v_mfma_f32_16x16x32_bf16 v[100:103], v[140:143], v[148:151], v[100:103]
ds_read_b128 v[188:191], v225 offset:7168
v_mfma_f32_16x16x32_bf16 v[68:71], v[136:139], v[148:151], v[68:71]
ds_read_b128 v[196:199], v227 offset:1024
v_mfma_f32_16x16x32_bf16 v[36:39], v[132:135], v[148:151], v[36:39]
ds_read_b128 v[200:203], v228 offset:1024
v_mfma_f32_16x16x32_bf16 v[4:7], v[128:131], v[148:151], v[4:7]
ds_read_b128 v[204:207], v229 offset:1024
s_waitcnt lgkmcnt(13)
v_mfma_f32_16x16x32_bf16 v[8:11], v[128:131], v[152:155], v[8:11]
ds_read_b128 v[208:211], v230 offset:1024
v_mfma_f32_16x16x32_bf16 v[40:43], v[132:135], v[152:155], v[40:43]
ds_read_b128 v[212:215], v231 offset:1024
v_mfma_f32_16x16x32_bf16 v[72:75], v[136:139], v[152:155], v[72:75]
ds_read_b128 v[216:219], v232 offset:1024
v_mfma_f32_16x16x32_bf16 v[104:107], v[140:143], v[152:155], v[104:107]
ds_read_b128 v[220:223], v233 offset:1024
s_waitcnt lgkmcnt(15)
v_mfma_f32_16x16x32_bf16 v[108:111], v[140:143], v[156:159], v[108:111]
v_mfma_f32_16x16x32_bf16 v[76:79], v[136:139], v[156:159], v[76:79]
v_mfma_f32_16x16x32_bf16 v[44:47], v[132:135], v[156:159], v[44:47]
v_mfma_f32_16x16x32_bf16 v[12:15], v[128:131], v[156:159], v[12:15]
s_waitcnt lgkmcnt(15)
v_mfma_f32_16x16x32_bf16 v[16:19], v[128:131], v[160:163], v[16:19]
v_mfma_f32_16x16x32_bf16 v[48:51], v[132:135], v[160:163], v[48:51]
v_mfma_f32_16x16x32_bf16 v[80:83], v[136:139], v[160:163], v[80:83]
v_mfma_f32_16x16x32_bf16 v[112:115], v[140:143], v[160:163], v[112:115]
s_waitcnt lgkmcnt(14)
v_mfma_f32_16x16x32_bf16 v[116:119], v[140:143], v[164:167], v[116:119]
v_mfma_f32_16x16x32_bf16 v[84:87], v[136:139], v[164:167], v[84:87]
v_mfma_f32_16x16x32_bf16 v[52:55], v[132:135], v[164:167], v[52:55]
v_mfma_f32_16x16x32_bf16 v[20:23], v[128:131], v[164:167], v[20:23]
s_waitcnt lgkmcnt(13)
v_mfma_f32_16x16x32_bf16 v[24:27], v[128:131], v[168:171], v[24:27]
v_mfma_f32_16x16x32_bf16 v[56:59], v[132:135], v[168:171], v[56:59]
v_mfma_f32_16x16x32_bf16 v[88:91], v[136:139], v[168:171], v[88:91]
v_mfma_f32_16x16x32_bf16 v[120:123], v[140:143], v[168:171], v[120:123]
s_waitcnt lgkmcnt(12)
v_mfma_f32_16x16x32_bf16 v[124:127], v[140:143], v[172:175], v[124:127]
v_mfma_f32_16x16x32_bf16 v[92:95], v[136:139], v[172:175], v[92:95]
v_mfma_f32_16x16x32_bf16 v[60:63], v[132:135], v[172:175], v[60:63]
v_mfma_f32_16x16x32_bf16 v[28:31], v[128:131], v[172:175], v[28:31]
s_waitcnt lgkmcnt(0)
s_barrier
v_mfma_f32_16x16x32_bf16 v[0:3], v[176:179], v[192:195], v[0:3]
ds_read_b128 v[128:131], v224 offset:0
v_mfma_f32_16x16x32_bf16 v[32:35], v[180:183], v[192:195], v[32:35]
ds_read_b128 v[144:147], v226 offset:16384
v_mfma_f32_16x16x32_bf16 v[64:67], v[184:187], v[192:195], v[64:67]
ds_read_b128 v[132:135], v224 offset:2048
v_mfma_f32_16x16x32_bf16 v[96:99], v[188:191], v[192:195], v[96:99]
ds_read_b128 v[136:139], v224 offset:4096
v_mfma_f32_16x16x32_bf16 v[100:103], v[188:191], v[196:199], v[100:103]
ds_read_b128 v[140:143], v224 offset:6144
v_mfma_f32_16x16x32_bf16 v[68:71], v[184:187], v[196:199], v[68:71]
ds_read_b128 v[148:151], v227 offset:16384
v_mfma_f32_16x16x32_bf16 v[36:39], v[180:183], v[196:199], v[36:39]
ds_read_b128 v[152:155], v228 offset:16384
v_mfma_f32_16x16x32_bf16 v[4:7], v[176:179], v[196:199], v[4:7]
ds_read_b128 v[156:159], v229 offset:16384
v_mfma_f32_16x16x32_bf16 v[8:11], v[176:179], v[200:203], v[8:11]
ds_read_b128 v[160:163], v230 offset:16384
v_mfma_f32_16x16x32_bf16 v[40:43], v[180:183], v[200:203], v[40:43]
ds_read_b128 v[164:167], v231 offset:16384
v_mfma_f32_16x16x32_bf16 v[72:75], v[184:187], v[200:203], v[72:75]
ds_read_b128 v[168:171], v232 offset:16384
v_mfma_f32_16x16x32_bf16 v[104:107], v[188:191], v[200:203], v[104:107]
ds_read_b128 v[172:175], v233 offset:16384
v_mfma_f32_16x16x32_bf16 v[108:111], v[188:191], v[204:207], v[108:111]
v_mfma_f32_16x16x32_bf16 v[76:79], v[184:187], v[204:207], v[76:79]
v_mfma_f32_16x16x32_bf16 v[44:47], v[180:183], v[204:207], v[44:47]
v_mfma_f32_16x16x32_bf16 v[12:15], v[176:179], v[204:207], v[12:15]
v_mfma_f32_16x16x32_bf16 v[16:19], v[176:179], v[208:211], v[16:19]
v_mfma_f32_16x16x32_bf16 v[48:51], v[180:183], v[208:211], v[48:51]
v_mfma_f32_16x16x32_bf16 v[80:83], v[184:187], v[208:211], v[80:83]
v_mfma_f32_16x16x32_bf16 v[112:115], v[188:191], v[208:211], v[112:115]
v_mfma_f32_16x16x32_bf16 v[116:119], v[188:191], v[212:215], v[116:119]
v_mfma_f32_16x16x32_bf16 v[84:87], v[184:187], v[212:215], v[84:87]
v_mfma_f32_16x16x32_bf16 v[52:55], v[180:183], v[212:215], v[52:55]
v_mfma_f32_16x16x32_bf16 v[20:23], v[176:179], v[212:215], v[20:23]
v_mfma_f32_16x16x32_bf16 v[24:27], v[176:179], v[216:219], v[24:27]
v_mfma_f32_16x16x32_bf16 v[56:59], v[180:183], v[216:219], v[56:59]
v_mfma_f32_16x16x32_bf16 v[88:91], v[184:187], v[216:219], v[88:91]
v_mfma_f32_16x16x32_bf16 v[120:123], v[188:191], v[216:219], v[120:123]
v_mfma_f32_16x16x32_bf16 v[124:127], v[188:191], v[220:223], v[124:127]
v_mfma_f32_16x16x32_bf16 v[92:95], v[184:187], v[220:223], v[92:95]
v_mfma_f32_16x16x32_bf16 v[60:63], v[180:183], v[220:223], v[60:63]
s_sub_u32 s19, s19, 1
s_cmp_lg_u32 s19, 0
v_mfma_f32_16x16x32_bf16 v[28:31], v[176:179], v[220:223], v[28:31]
s_cbranch_scc1 p2_c0
s_waitcnt lgkmcnt(0)
s_barrier
s_nop 7
v_lshrrev_b32 v218, 4, v250
v_mul_u32_u24 v218, 28672, v218
v_and_b32 v219, 15, v250
v_lshl_add_u32 v219, v219, 4, v218
s_lshl_b32 s36, s44, 2
s_add_u32 s36, s36, s17
s_mul_i32 s36, s36, 458752
s_lshl_b32 s37, s45, 8
s_add_u32 s36, s36, s37
s_add_u32 s37, s36, 0
v_cvt_pk_bf16_f32 v128, v0, v4
v_cvt_pk_bf16_f32 v129, v8, v12
v_cvt_pk_bf16_f32 v130, v16, v20
v_cvt_pk_bf16_f32 v131, v24, v28
buffer_store_dwordx4 v[128:131], v219, s[12:15], s37 offen nt
s_add_u32 s37, s36, 7168
v_cvt_pk_bf16_f32 v132, v1, v5
v_cvt_pk_bf16_f32 v133, v9, v13
v_cvt_pk_bf16_f32 v134, v17, v21
v_cvt_pk_bf16_f32 v135, v25, v29
buffer_store_dwordx4 v[132:135], v219, s[12:15], s37 offen nt
s_add_u32 s37, s36, 14336
v_cvt_pk_bf16_f32 v136, v2, v6
v_cvt_pk_bf16_f32 v137, v10, v14
v_cvt_pk_bf16_f32 v138, v18, v22
v_cvt_pk_bf16_f32 v139, v26, v30
buffer_store_dwordx4 v[136:139], v219, s[12:15], s37 offen nt
s_add_u32 s37, s36, 21504
v_cvt_pk_bf16_f32 v140, v3, v7
v_cvt_pk_bf16_f32 v141, v11, v15
v_cvt_pk_bf16_f32 v142, v19, v23
v_cvt_pk_bf16_f32 v143, v27, v31
buffer_store_dwordx4 v[140:143], v219, s[12:15], s37 offen nt
s_add_u32 s37, s36, 114688
v_cvt_pk_bf16_f32 v144, v32, v36
v_cvt_pk_bf16_f32 v145, v40, v44
v_cvt_pk_bf16_f32 v146, v48, v52
v_cvt_pk_bf16_f32 v147, v56, v60
buffer_store_dwordx4 v[144:147], v219, s[12:15], s37 offen nt
s_add_u32 s37, s36, 121856
v_cvt_pk_bf16_f32 v148, v33, v37
v_cvt_pk_bf16_f32 v149, v41, v45
v_cvt_pk_bf16_f32 v150, v49, v53
v_cvt_pk_bf16_f32 v151, v57, v61
buffer_store_dwordx4 v[148:151], v219, s[12:15], s37 offen nt
s_add_u32 s37, s36, 129024
v_cvt_pk_bf16_f32 v152, v34, v38
v_cvt_pk_bf16_f32 v153, v42, v46
v_cvt_pk_bf16_f32 v154, v50, v54
v_cvt_pk_bf16_f32 v155, v58, v62
buffer_store_dwordx4 v[152:155], v219, s[12:15], s37 offen nt
s_add_u32 s37, s36, 136192
v_cvt_pk_bf16_f32 v156, v35, v39
v_cvt_pk_bf16_f32 v157, v43, v47
v_cvt_pk_bf16_f32 v158, v51, v55
v_cvt_pk_bf16_f32 v159, v59, v63
buffer_store_dwordx4 v[156:159], v219, s[12:15], s37 offen nt
s_add_u32 s37, s36, 229376
v_cvt_pk_bf16_f32 v160, v64, v68
v_cvt_pk_bf16_f32 v161, v72, v76
v_cvt_pk_bf16_f32 v162, v80, v84
v_cvt_pk_bf16_f32 v163, v88, v92
buffer_store_dwordx4 v[160:163], v219, s[12:15], s37 offen nt
s_add_u32 s37, s36, 236544
v_cvt_pk_bf16_f32 v164, v65, v69
v_cvt_pk_bf16_f32 v165, v73, v77
v_cvt_pk_bf16_f32 v166, v81, v85
v_cvt_pk_bf16_f32 v167, v89, v93
buffer_store_dwordx4 v[164:167], v219, s[12:15], s37 offen nt
s_add_u32 s37, s36, 243712
v_cvt_pk_bf16_f32 v168, v66, v70
v_cvt_pk_bf16_f32 v169, v74, v78
v_cvt_pk_bf16_f32 v170, v82, v86
v_cvt_pk_bf16_f32 v171, v90, v94
buffer_store_dwordx4 v[168:171], v219, s[12:15], s37 offen nt
s_add_u32 s37, s36, 250880
v_cvt_pk_bf16_f32 v172, v67, v71
v_cvt_pk_bf16_f32 v173, v75, v79
v_cvt_pk_bf16_f32 v174, v83, v87
v_cvt_pk_bf16_f32 v175, v91, v95
buffer_store_dwordx4 v[172:175], v219, s[12:15], s37 offen nt
s_add_u32 s37, s36, 344064
v_cvt_pk_bf16_f32 v176, v96, v100
v_cvt_pk_bf16_f32 v177, v104, v108
v_cvt_pk_bf16_f32 v178, v112, v116
v_cvt_pk_bf16_f32 v179, v120, v124
buffer_store_dwordx4 v[176:179], v219, s[12:15], s37 offen nt
s_add_u32 s37, s36, 351232
v_cvt_pk_bf16_f32 v180, v97, v101
v_cvt_pk_bf16_f32 v181, v105, v109
v_cvt_pk_bf16_f32 v182, v113, v117
v_cvt_pk_bf16_f32 v183, v121, v125
buffer_store_dwordx4 v[180:183], v219, s[12:15], s37 offen nt
s_add_u32 s37, s36, 358400
v_cvt_pk_bf16_f32 v184, v98, v102
v_cvt_pk_bf16_f32 v185, v106, v110
v_cvt_pk_bf16_f32 v186, v114, v118
v_cvt_pk_bf16_f32 v187, v122, v126
buffer_store_dwordx4 v[184:187], v219, s[12:15], s37 offen nt
s_add_u32 s37, s36, 365568
v_cvt_pk_bf16_f32 v188, v99, v103
v_cvt_pk_bf16_f32 v189, v107, v111
v_cvt_pk_bf16_f32 v190, v115, v119
v_cvt_pk_bf16_f32 v191, v123, v127
buffer_store_dwordx4 v[188:191], v219, s[12:15], s37 offen nt
s_endpgm
L_xr:
s_waitcnt lgkmcnt(0)
s_mov_b32 s4, s56
s_mov_b32 s5, s57
s_mov_b32 s6, 2097152
s_mov_b32 s7, 0x20000
s_mov_b32 s8, s48
s_mov_b32 s9, s49
s_mov_b32 s10, 4194304
s_mov_b32 s11, 0x20000
s_add_u32 s12, s64, 16777216
s_addc_u32 s13, s65, 0
s_mov_b32 s14, 4194304
s_mov_b32 s15, 0x20000
s_mov_b32 s46, 0
s_cmp_ge_u32 s16, 4
s_cbranch_scc1 L_xc
s_mov_b32 s17, s16
L_xp:
s_and_b32 s45, s43, 1
s_bfe_u32 s44, s43, 0x10001
s_xor_b32 s22, s44, s45
s_lshl_b32 s47, s42, 1
s_add_u32 s45, s45, s47
s_lshr_b32 s47, s42, 2
s_xor_b32 s47, s46, s47
s_and_b32 s47, s47, 1
s_lshl_b32 s47, s47, 1
s_add_u32 s44, s44, s47
s_and_b32 s23, s42, 3
s_lshl_b32 s23, s23, 2
s_lshl_b32 s20, s44, 9
s_lshl_b32 s21, s45, 18
v_and_b32 v1, 63, v0
s_mul_i32 s19, s17, 16
s_add_u32 s19, s19, 0
v_lshrrev_b32 v2, 5, v1
v_add_u32 v2, s19, v2
v_and_b32 v3, 31, v1
v_and_b32 v4, 3, v2
v_bfe_u32 v5, v2, 3, 1
v_lshl_add_u32 v4, v5, 2, v4
v_lshlrev_b32 v4, 1, v4
v_xor_b32 v3, v3, v4
v_mul_u32_u24 v2, 2048, v2
v_lshl_add_u32 v2, v3, 4, v2
v_add_u32 v8, s20, v2
s_mul_i32 s19, s17, 16
s_add_u32 s19, s19, 2
v_lshrrev_b32 v2, 5, v1
v_add_u32 v2, s19, v2
v_and_b32 v3, 31, v1
v_and_b32 v4, 3, v2
v_bfe_u32 v5, v2, 3, 1
v_lshl_add_u32 v4, v5, 2, v4
v_lshlrev_b32 v4, 1, v4
v_xor_b32 v3, v3, v4
v_mul_u32_u24 v2, 2048, v2
v_lshl_add_u32 v2, v3, 4, v2
v_add_u32 v9, s20, v2
s_mul_i32 s19, s17, 16
s_add_u32 s19, s19, 4
v_lshrrev_b32 v2, 5, v1
v_add_u32 v2, s19, v2
v_and_b32 v3, 31, v1
v_and_b32 v4, 3, v2
v_bfe_u32 v5, v2, 3, 1
v_lshl_add_u32 v4, v5, 2, v4
v_lshlrev_b32 v4, 1, v4
v_xor_b32 v3, v3, v4
v_mul_u32_u24 v2, 2048, v2
v_lshl_add_u32 v2, v3, 4, v2
v_add_u32 v10, s20, v2
s_mul_i32 s19, s17, 16
s_add_u32 s19, s19, 6
v_lshrrev_b32 v2, 5, v1
v_add_u32 v2, s19, v2
v_and_b32 v3, 31, v1
v_and_b32 v4, 3, v2
v_bfe_u32 v5, v2, 3, 1
v_lshl_add_u32 v4, v5, 2, v4
v_lshlrev_b32 v4, 1, v4
v_xor_b32 v3, v3, v4
v_mul_u32_u24 v2, 2048, v2
v_lshl_add_u32 v2, v3, 4, v2
v_add_u32 v11, s20, v2
s_mul_i32 s19, s17, 16
s_add_u32 s19, s19, 8
v_lshrrev_b32 v2, 5, v1
v_add_u32 v2, s19, v2
v_and_b32 v3, 31, v1
v_and_b32 v4, 3, v2
v_bfe_u32 v5, v2, 3, 1
v_lshl_add_u32 v4, v5, 2, v4
v_lshlrev_b32 v4, 1, v4
v_xor_b32 v3, v3, v4
v_mul_u32_u24 v2, 2048, v2
v_lshl_add_u32 v2, v3, 4, v2
v_add_u32 v12, s20, v2
s_mul_i32 s19, s17, 16
s_add_u32 s19, s19, 10
v_lshrrev_b32 v2, 5, v1
v_add_u32 v2, s19, v2
v_and_b32 v3, 31, v1
v_and_b32 v4, 3, v2
v_bfe_u32 v5, v2, 3, 1
v_lshl_add_u32 v4, v5, 2, v4
v_lshlrev_b32 v4, 1, v4
v_xor_b32 v3, v3, v4
v_mul_u32_u24 v2, 2048, v2
v_lshl_add_u32 v2, v3, 4, v2
v_add_u32 v13, s20, v2
s_mul_i32 s19, s17, 16
s_add_u32 s19, s19, 12
v_lshrrev_b32 v2, 5, v1
v_add_u32 v2, s19, v2
v_and_b32 v3, 31, v1
v_and_b32 v4, 3, v2
v_bfe_u32 v5, v2, 3, 1
v_lshl_add_u32 v4, v5, 2, v4
v_lshlrev_b32 v4, 1, v4
v_xor_b32 v3, v3, v4
v_mul_u32_u24 v2, 2048, v2
v_lshl_add_u32 v2, v3, 4, v2
v_add_u32 v14, s20, v2
s_mul_i32 s19, s17, 16
s_add_u32 s19, s19, 14
v_lshrrev_b32 v2, 5, v1
v_add_u32 v2, s19, v2
v_and_b32 v3, 31, v1
v_and_b32 v4, 3, v2
v_bfe_u32 v5, v2, 3, 1
v_lshl_add_u32 v4, v5, 2, v4
v_lshlrev_b32 v4, 1, v4
v_xor_b32 v3, v3, v4
v_mul_u32_u24 v2, 2048, v2
v_lshl_add_u32 v2, v3, 4, v2
v_add_u32 v15, s20, v2
s_mul_i32 s19, s17, 32
v_lshrrev_b32 v2, 2, v1
v_add_u32 v2, s19, v2
v_mul_u32_u24 v2, 2048, v2
v_lshrrev_b32 v3, 4, v1
v_sub_u32 v3, 0, v3
v_xor_b32 v3, v3, v1
v_and_b32 v3, 3, v3
v_lshl_add_u32 v2, v3, 4, v2
v_add_u32 v2, s21, v2
v_add_u32 v16, 0, v2
v_add_u32 v17, 64, v2
v_add_u32 v18, 32768, v2
v_add_u32 v19, 32832, v2
s_mul_i32 s32, s17, 8192
s_mul_i32 s33, s17, 4096
s_add_u32 s33, s33, 98304
s_mov_b32 s34, 0
s_mov_b32 s35, 2
px_pl_27:
s_add_u32 s37, s22, 14
s_cmp_gt_u32 s34, s37
s_cselect_b32 s37, 0, 1
s_sub_u32 s37, s34, s37
s_and_b32 s36, s37, 1
s_cmp_eq_u32 s36, s22
s_cselect_b32 s36, 2, 0
s_add_u32 s36, s36, s37
s_cmp_eq_u32 s34, 0
s_cselect_b32 s36, s22, s36
s_add_u32 s36, s36, s23
s_sub_u32 s37, s36, 16
s_cmp_ge_u32 s36, 16
s_cselect_b32 s36, s37, s36
s_mul_i32 s39, s36, 128
s_mul_i32 s41, s35, 16384
s_add_u32 s41, s41, s33
s_mul_i32 s38, s36, 131072
s_mul_i32 s40, s35, 32768
s_add_u32 s40, s40, s32
s_add_u32 m0, s41, 0
s_nop 0
buffer_load_dwordx4 v16, s[8:11], s39 offen  lds
s_add_u32 m0, s41, 1024
s_nop 0
buffer_load_dwordx4 v17, s[8:11], s39 offen  lds
s_add_u32 m0, s41, 2048
s_nop 0
buffer_load_dwordx4 v18, s[8:11], s39 offen  lds
s_add_u32 m0, s41, 3072
s_nop 0
buffer_load_dwordx4 v19, s[8:11], s39 offen  lds
s_add_u32 m0, s40, 0
s_nop 0
buffer_load_dwordx4 v8, s[4:7], s38 offen  lds
s_add_u32 m0, s40, 1024
s_nop 0
buffer_load_dwordx4 v9, s[4:7], s38 offen  lds
s_add_u32 m0, s40, 2048
s_nop 0
buffer_load_dwordx4 v10, s[4:7], s38 offen  lds
s_add_u32 m0, s40, 3072
s_nop 0
buffer_load_dwordx4 v11, s[4:7], s38 offen  lds
s_add_u32 m0, s40, 4096
s_nop 0
buffer_load_dwordx4 v12, s[4:7], s38 offen  lds
s_add_u32 m0, s40, 5120
s_nop 0
buffer_load_dwordx4 v13, s[4:7], s38 offen  lds
s_add_u32 m0, s40, 6144
s_nop 0
buffer_load_dwordx4 v14, s[4:7], s38 offen  lds
s_add_u32 m0, s40, 7168
s_nop 0
buffer_load_dwordx4 v15, s[4:7], s38 offen  lds
s_add_u32 s34, s34, 1
s_add_u32 s35, s35, 1
s_cmp_eq_u32 s35, 3
s_cselect_b32 s35, 0, s35
s_cmp_lt_u32 s34, 2
s_cbranch_scc1 px_pl_27
s_waitcnt vmcnt(12)
s_barrier
s_cmp_lt_u32 s34, 16
s_cbranch_scc1 px_pl_27
s_waitcnt vmcnt(0)
s_barrier
s_waitcnt vmcnt(0)
s_barrier
s_barrier
s_add_u32 s46, s46, 1
s_cmp_lt_u32 s46, 2
s_cbranch_scc1 L_xp
s_endpgm
L_xc:
v_and_b32 v250, 63, v0
s_bfe_u32 s17, s16, 0x10001
s_and_b32 s18, s16, 1
s_mov_b32 s28, s62
s_mov_b32 s29, s63
s_mov_b32 s30, 256
s_mov_b32 s31, 0x20000
s_add_u32 s24, s64, 25165824
s_addc_u32 s25, s65, 0
s_mov_b32 s26, 32768
s_mov_b32 s27, 0x20000
L_xc2:
s_and_b32 s45, s43, 1
s_bfe_u32 s44, s43, 0x10001
s_xor_b32 s22, s44, s45
s_lshl_b32 s47, s42, 1
s_add_u32 s45, s45, s47
s_lshr_b32 s47, s42, 2
s_xor_b32 s47, s46, s47
s_and_b32 s47, s47, 1
s_lshl_b32 s47, s47, 1
s_add_u32 s44, s44, s47
s_and_b32 s23, s42, 3
s_lshl_b32 s23, s23, 2
s_lshl_b32 s20, s44, 9
s_lshl_b32 s21, s45, 18
v_lshrrev_b32 v129, 4, v250
v_bfe_u32 v130, v250, 2, 2
v_and_b32 v131, 3, v250
v_lshl_add_u32 v132, v129, 3, v130
v_mul_u32_u24 v132, 512, v132
v_and_b32 v133, 1, v129
v_lshl_add_u32 v133, v133, 2, v130
v_lshlrev_b32 v133, 1, v133
v_lshl_add_u32 v132, v131, 3, v132
s_mul_i32 s19, s17, 16
s_add_u32 s36, s19, 0
v_xor_b32 v134, s36, v133
v_lshl_add_u32 v134, v134, 4, v132
v_add_u32 v224, 0, v134
v_add_u32 v225, 65536, v134
s_add_u32 s36, s19, 2
v_xor_b32 v134, s36, v133
v_lshl_add_u32 v134, v134, 4, v132
v_add_u32 v226, 0, v134
v_add_u32 v227, 65536, v134
s_add_u32 s36, s19, 4
v_xor_b32 v134, s36, v133
v_lshl_add_u32 v134, v134, 4, v132
v_add_u32 v228, 0, v134
v_add_u32 v229, 65536, v134
s_add_u32 s36, s19, 6
v_xor_b32 v134, s36, v133
v_lshl_add_u32 v134, v134, 4, v132
v_add_u32 v230, 0, v134
v_add_u32 v231, 65536, v134
s_add_u32 s36, s19, 8
v_xor_b32 v134, s36, v133
v_lshl_add_u32 v134, v134, 4, v132
v_add_u32 v232, 0, v134
v_add_u32 v233, 65536, v134
s_add_u32 s36, s19, 10
v_xor_b32 v134, s36, v133
v_lshl_add_u32 v134, v134, 4, v132
v_add_u32 v234, 0, v134
v_add_u32 v235, 65536, v134
s_add_u32 s36, s19, 12
v_xor_b32 v134, s36, v133
v_lshl_add_u32 v134, v134, 4, v132
v_add_u32 v236, 0, v134
v_add_u32 v237, 65536, v134
s_add_u32 s36, s19, 14
v_xor_b32 v134, s36, v133
v_lshl_add_u32 v134, v134, 4, v132
v_add_u32 v238, 0, v134
v_add_u32 v239, 65536, v134
s_mul_i32 s19, s18, 8192
v_and_b32 v129, 15, v250
v_lshl_add_u32 v134, v129, 6, s19
v_lshrrev_b32 v129, 2, v129
v_sub_u32 v129, 0, v129
v_lshrrev_b32 v130, 4, v250
v_xor_b32 v129, v129, v130
v_and_b32 v129, 3, v129
v_lshl_add_u32 v134, v129, 4, v134
v_add_u32 v240, 65536, v134
v_add_u32 v241, 131072, v134
v_mov_b64 v[0:1], 0
v_mov_b64 v[2:3], 0
v_mov_b64 v[4:5], 0
v_mov_b64 v[6:7], 0
v_mov_b64 v[8:9], 0
v_mov_b64 v[10:11], 0
v_mov_b64 v[12:13], 0
v_mov_b64 v[14:15], 0
v_mov_b64 v[16:17], 0
v_mov_b64 v[18:19], 0
v_mov_b64 v[20:21], 0
v_mov_b64 v[22:23], 0
v_mov_b64 v[24:25], 0
v_mov_b64 v[26:27], 0
v_mov_b64 v[28:29], 0
v_mov_b64 v[30:31], 0
v_mov_b64 v[32:33], 0
v_mov_b64 v[34:35], 0
v_mov_b64 v[36:37], 0
v_mov_b64 v[38:39], 0
v_mov_b64 v[40:41], 0
v_mov_b64 v[42:43], 0
v_mov_b64 v[44:45], 0
v_mov_b64 v[46:47], 0
v_mov_b64 v[48:49], 0
v_mov_b64 v[50:51], 0
v_mov_b64 v[52:53], 0
v_mov_b64 v[54:55], 0
v_mov_b64 v[56:57], 0
v_mov_b64 v[58:59], 0
v_mov_b64 v[60:61], 0
v_mov_b64 v[62:63], 0
v_mov_b64 v[64:65], 0
v_mov_b64 v[66:67], 0
v_mov_b64 v[68:69], 0
v_mov_b64 v[70:71], 0
v_mov_b64 v[72:73], 0
v_mov_b64 v[74:75], 0
v_mov_b64 v[76:77], 0
v_mov_b64 v[78:79], 0
v_mov_b64 v[80:81], 0
v_mov_b64 v[82:83], 0
v_mov_b64 v[84:85], 0
v_mov_b64 v[86:87], 0
v_mov_b64 v[88:89], 0
v_mov_b64 v[90:91], 0
v_mov_b64 v[92:93], 0
v_mov_b64 v[94:95], 0
v_mov_b64 v[96:97], 0
v_mov_b64 v[98:99], 0
v_mov_b64 v[100:101], 0
v_mov_b64 v[102:103], 0
v_mov_b64 v[104:105], 0
v_mov_b64 v[106:107], 0
v_mov_b64 v[108:109], 0
v_mov_b64 v[110:111], 0
v_mov_b64 v[112:113], 0
v_mov_b64 v[114:115], 0
v_mov_b64 v[116:117], 0
v_mov_b64 v[118:119], 0
v_mov_b64 v[120:121], 0
v_mov_b64 v[122:123], 0
v_mov_b64 v[124:125], 0
v_mov_b64 v[126:127], 0
s_waitcnt lgkmcnt(0)
s_barrier
ds_read_b64_tr_b16 v[128:129], v225 offset:0
ds_read_b64_tr_b16 v[130:131], v225 offset:2048
ds_read_b128 v[160:163], v241 offset:0
ds_read_b128 v[164:167], v241 offset:2048
ds_read_b128 v[168:171], v241 offset:4096
ds_read_b128 v[172:175], v241 offset:6144
ds_read_b64_tr_b16 v[132:133], v227 offset:0
ds_read_b64_tr_b16 v[134:135], v227 offset:2048
ds_read_b64_tr_b16 v[136:137], v229 offset:0
ds_read_b64_tr_b16 v[138:139], v229 offset:2048
ds_read_b64_tr_b16 v[140:141], v231 offset:0
ds_read_b64_tr_b16 v[142:143], v231 offset:2048
ds_read_b64_tr_b16 v[144:145], v233 offset:0
ds_read_b64_tr_b16 v[146:147], v233 offset:2048
ds_read_b64_tr_b16 v[148:149], v235 offset:0
ds_read_b64_tr_b16 v[150:151], v235 offset:2048
ds_read_b64_tr_b16 v[152:153], v237 offset:0
ds_read_b64_tr_b16 v[154:155], v237 offset:2048
ds_read_b64_tr_b16 v[156:157], v239 offset:0
ds_read_b64_tr_b16 v[158:159], v239 offset:2048
s_mov_b32 s19, 6
s_branch px_c2
.p2align 6
px_c0:
s_waitcnt lgkmcnt(15)
v_mfma_f32_16x16x32_bf16 v[0:3], v[128:131], v[160:163], v[0:3]
ds_read_b64_tr_b16 v[176:177], v224 offset:16384
s_waitcnt lgkmcnt(15)
v_mfma_f32_16x16x32_bf16 v[4:7], v[128:131], v[164:167], v[4:7]
ds_read_b64_tr_b16 v[178:179], v224 offset:18432
s_waitcnt lgkmcnt(15)
v_mfma_f32_16x16x32_bf16 v[8:11], v[128:131], v[168:171], v[8:11]
ds_read_b128 v[208:211], v240 offset:33792
s_waitcnt lgkmcnt(15)
v_mfma_f32_16x16x32_bf16 v[12:15], v[128:131], v[172:175], v[12:15]
ds_read_b128 v[212:215], v240 offset:35840
s_waitcnt lgkmcnt(15)
v_mfma_f32_16x16x32_bf16 v[28:31], v[132:135], v[172:175], v[28:31]
ds_read_b128 v[216:219], v240 offset:37888
v_mfma_f32_16x16x32_bf16 v[24:27], v[132:135], v[168:171], v[24:27]
ds_read_b128 v[220:223], v240 offset:39936
v_mfma_f32_16x16x32_bf16 v[20:23], v[132:135], v[164:167], v[20:23]
ds_read_b64_tr_b16 v[180:181], v226 offset:16384
v_mfma_f32_16x16x32_bf16 v[16:19], v[132:135], v[160:163], v[16:19]
ds_read_b64_tr_b16 v[182:183], v226 offset:18432
s_waitcnt lgkmcnt(15)
v_mfma_f32_16x16x32_bf16 v[32:35], v[136:139], v[160:163], v[32:35]
ds_read_b64_tr_b16 v[184:185], v228 offset:16384
v_mfma_f32_16x16x32_bf16 v[36:39], v[136:139], v[164:167], v[36:39]
ds_read_b64_tr_b16 v[186:187], v228 offset:18432
v_mfma_f32_16x16x32_bf16 v[40:43], v[136:139], v[168:171], v[40:43]
ds_read_b64_tr_b16 v[188:189], v230 offset:16384
v_mfma_f32_16x16x32_bf16 v[44:47], v[136:139], v[172:175], v[44:47]
ds_read_b64_tr_b16 v[190:191], v230 offset:18432
s_waitcnt lgkmcnt(15)
v_mfma_f32_16x16x32_bf16 v[60:63], v[140:143], v[172:175], v[60:63]
ds_read_b64_tr_b16 v[192:193], v232 offset:16384
v_mfma_f32_16x16x32_bf16 v[56:59], v[140:143], v[168:171], v[56:59]
ds_read_b64_tr_b16 v[194:195], v232 offset:18432
v_mfma_f32_16x16x32_bf16 v[52:55], v[140:143], v[164:167], v[52:55]
ds_read_b64_tr_b16 v[196:197], v234 offset:16384
v_mfma_f32_16x16x32_bf16 v[48:51], v[140:143], v[160:163], v[48:51]
ds_read_b64_tr_b16 v[198:199], v234 offset:18432
s_waitcnt lgkmcnt(15)
v_mfma_f32_16x16x32_bf16 v[64:67], v[144:147], v[160:163], v[64:67]
ds_read_b64_tr_b16 v[200:201], v236 offset:16384
v_mfma_f32_16x16x32_bf16 v[68:71], v[144:147], v[164:167], v[68:71]
ds_read_b64_tr_b16 v[202:203], v236 offset:18432
v_mfma_f32_16x16x32_bf16 v[72:75], v[144:147], v[168:171], v[72:75]
ds_read_b64_tr_b16 v[204:205], v238 offset:16384
v_mfma_f32_16x16x32_bf16 v[76:79], v[144:147], v[172:175], v[76:79]
ds_read_b64_tr_b16 v[206:207], v238 offset:18432
s_waitcnt lgkmcnt(15)
v_mfma_f32_16x16x32_bf16 v[92:95], v[148:151], v[172:175], v[92:95]
v_mfma_f32_16x16x32_bf16 v[88:91], v[148:151], v[168:171], v[88:91]
v_mfma_f32_16x16x32_bf16 v[84:87], v[148:151], v[164:167], v[84:87]
v_mfma_f32_16x16x32_bf16 v[80:83], v[148:151], v[160:163], v[80:83]
s_waitcnt lgkmcnt(15)
v_mfma_f32_16x16x32_bf16 v[96:99], v[152:155], v[160:163], v[96:99]
v_mfma_f32_16x16x32_bf16 v[100:103], v[152:155], v[164:167], v[100:103]
v_mfma_f32_16x16x32_bf16 v[104:107], v[152:155], v[168:171], v[104:107]
v_mfma_f32_16x16x32_bf16 v[108:111], v[152:155], v[172:175], v[108:111]
s_waitcnt lgkmcnt(15)
v_mfma_f32_16x16x32_bf16 v[124:127], v[156:159], v[172:175], v[124:127]
v_mfma_f32_16x16x32_bf16 v[120:123], v[156:159], v[168:171], v[120:123]
v_mfma_f32_16x16x32_bf16 v[116:119], v[156:159], v[164:167], v[116:119]
v_mfma_f32_16x16x32_bf16 v[112:115], v[156:159], v[160:163], v[112:115]
s_waitcnt lgkmcnt(0)
s_barrier
v_mfma_f32_16x16x32_bf16 v[0:3], v[176:179], v[208:211], v[0:3]
ds_read_b64_tr_b16 v[128:129], v224 offset:32768
v_mfma_f32_16x16x32_bf16 v[4:7], v[176:179], v[212:215], v[4:7]
ds_read_b64_tr_b16 v[130:131], v224 offset:34816
v_mfma_f32_16x16x32_bf16 v[8:11], v[176:179], v[216:219], v[8:11]
ds_read_b128 v[160:163], v240 offset:49152
v_mfma_f32_16x16x32_bf16 v[12:15], v[176:179], v[220:223], v[12:15]
ds_read_b128 v[164:167], v240 offset:51200
v_mfma_f32_16x16x32_bf16 v[28:31], v[180:183], v[220:223], v[28:31]
ds_read_b128 v[168:171], v240 offset:53248
v_mfma_f32_16x16x32_bf16 v[24:27], v[180:183], v[216:219], v[24:27]
ds_read_b128 v[172:175], v240 offset:55296
v_mfma_f32_16x16x32_bf16 v[20:23], v[180:183], v[212:215], v[20:23]
ds_read_b64_tr_b16 v[132:133], v226 offset:32768
v_mfma_f32_16x16x32_bf16 v[16:19], v[180:183], v[208:211], v[16:19]
ds_read_b64_tr_b16 v[134:135], v226 offset:34816
v_mfma_f32_16x16x32_bf16 v[32:35], v[184:187], v[208:211], v[32:35]
ds_read_b64_tr_b16 v[136:137], v228 offset:32768
v_mfma_f32_16x16x32_bf16 v[36:39], v[184:187], v[212:215], v[36:39]
ds_read_b64_tr_b16 v[138:139], v228 offset:34816
v_mfma_f32_16x16x32_bf16 v[40:43], v[184:187], v[216:219], v[40:43]
ds_read_b64_tr_b16 v[140:141], v230 offset:32768
v_mfma_f32_16x16x32_bf16 v[44:47], v[184:187], v[220:223], v[44:47]
ds_read_b64_tr_b16 v[142:143], v230 offset:34816
v_mfma_f32_16x16x32_bf16 v[60:63], v[188:191], v[220:223], v[60:63]
ds_read_b64_tr_b16 v[144:145], v232 offset:32768
v_mfma_f32_16x16x32_bf16 v[56:59], v[188:191], v[216:219], v[56:59]
ds_read_b64_tr_b16 v[146:147], v232 offset:34816
v_mfma_f32_16x16x32_bf16 v[52:55], v[188:191], v[212:215], v[52:55]
ds_read_b64_tr_b16 v[148:149], v234 offset:32768
v_mfma_f32_16x16x32_bf16 v[48:51], v[188:191], v[208:211], v[48:51]
ds_read_b64_tr_b16 v[150:151], v234 offset:34816
v_mfma_f32_16x16x32_bf16 v[64:67], v[192:195], v[208:211], v[64:67]
ds_read_b64_tr_b16 v[152:153], v236 offset:32768
v_mfma_f32_16x16x32_bf16 v[68:71], v[192:195], v[212:215], v[68:71]
ds_read_b64_tr_b16 v[154:155], v236 offset:34816
v_mfma_f32_16x16x32_bf16 v[72:75], v[192:195], v[216:219], v[72:75]
ds_read_b64_tr_b16 v[156:157], v238 offset:32768
v_mfma_f32_16x16x32_bf16 v[76:79], v[192:195], v[220:223], v[76:79]
ds_read_b64_tr_b16 v[158:159], v238 offset:34816
v_mfma_f32_16x16x32_bf16 v[92:95], v[196:199], v[220:223], v[92:95]
v_mfma_f32_16x16x32_bf16 v[88:91], v[196:199], v[216:219], v[88:91]
v_mfma_f32_16x16x32_bf16 v[84:87], v[196:199], v[212:215], v[84:87]
v_mfma_f32_16x16x32_bf16 v[80:83], v[196:199], v[208:211], v[80:83]
v_mfma_f32_16x16x32_bf16 v[96:99], v[200:203], v[208:211], v[96:99]
v_mfma_f32_16x16x32_bf16 v[100:103], v[200:203], v[212:215], v[100:103]
v_mfma_f32_16x16x32_bf16 v[104:107], v[200:203], v[216:219], v[104:107]
v_mfma_f32_16x16x32_bf16 v[108:111], v[200:203], v[220:223], v[108:111]
v_mfma_f32_16x16x32_bf16 v[124:127], v[204:207], v[220:223], v[124:127]
v_mfma_f32_16x16x32_bf16 v[120:123], v[204:207], v[216:219], v[120:123]
v_mfma_f32_16x16x32_bf16 v[116:119], v[204:207], v[212:215], v[116:119]
v_mfma_f32_16x16x32_bf16 v[112:115], v[204:207], v[208:211], v[112:115]
px_c1:
s_waitcnt lgkmcnt(15)
v_mfma_f32_16x16x32_bf16 v[0:3], v[128:131], v[160:163], v[0:3]
ds_read_b64_tr_b16 v[176:177], v224 offset:49152
s_waitcnt lgkmcnt(15)
v_mfma_f32_16x16x32_bf16 v[4:7], v[128:131], v[164:167], v[4:7]
ds_read_b64_tr_b16 v[178:179], v224 offset:51200
s_waitcnt lgkmcnt(15)
v_mfma_f32_16x16x32_bf16 v[8:11], v[128:131], v[168:171], v[8:11]
ds_read_b128 v[208:211], v240 offset:50176
s_waitcnt lgkmcnt(15)
v_mfma_f32_16x16x32_bf16 v[12:15], v[128:131], v[172:175], v[12:15]
ds_read_b128 v[212:215], v240 offset:52224
s_waitcnt lgkmcnt(15)
v_mfma_f32_16x16x32_bf16 v[28:31], v[132:135], v[172:175], v[28:31]
ds_read_b128 v[216:219], v240 offset:54272
v_mfma_f32_16x16x32_bf16 v[24:27], v[132:135], v[168:171], v[24:27]
ds_read_b128 v[220:223], v240 offset:56320
v_mfma_f32_16x16x32_bf16 v[20:23], v[132:135], v[164:167], v[20:23]
ds_read_b64_tr_b16 v[180:181], v226 offset:49152
v_mfma_f32_16x16x32_bf16 v[16:19], v[132:135], v[160:163], v[16:19]
ds_read_b64_tr_b16 v[182:183], v226 offset:51200
s_waitcnt lgkmcnt(15)
v_mfma_f32_16x16x32_bf16 v[32:35], v[136:139], v[160:163], v[32:35]
ds_read_b64_tr_b16 v[184:185], v228 offset:49152
v_mfma_f32_16x16x32_bf16 v[36:39], v[136:139], v[164:167], v[36:39]
ds_read_b64_tr_b16 v[186:187], v228 offset:51200
v_mfma_f32_16x16x32_bf16 v[40:43], v[136:139], v[168:171], v[40:43]
ds_read_b64_tr_b16 v[188:189], v230 offset:49152
v_mfma_f32_16x16x32_bf16 v[44:47], v[136:139], v[172:175], v[44:47]
ds_read_b64_tr_b16 v[190:191], v230 offset:51200
s_waitcnt lgkmcnt(15)
v_mfma_f32_16x16x32_bf16 v[60:63], v[140:143], v[172:175], v[60:63]
ds_read_b64_tr_b16 v[192:193], v232 offset:49152
v_mfma_f32_16x16x32_bf16 v[56:59], v[140:143], v[168:171], v[56:59]
ds_read_b64_tr_b16 v[194:195], v232 offset:51200
v_mfma_f32_16x16x32_bf16 v[52:55], v[140:143], v[164:167], v[52:55]
ds_read_b64_tr_b16 v[196:197], v234 offset:49152
v_mfma_f32_16x16x32_bf16 v[48:51], v[140:143], v[160:163], v[48:51]
ds_read_b64_tr_b16 v[198:199], v234 offset:51200
s_waitcnt lgkmcnt(15)
v_mfma_f32_16x16x32_bf16 v[64:67], v[144:147], v[160:163], v[64:67]
ds_read_b64_tr_b16 v[200:201], v236 offset:49152
v_mfma_f32_16x16x32_bf16 v[68:71], v[144:147], v[164:167], v[68:71]
ds_read_b64_tr_b16 v[202:203], v236 offset:51200
v_mfma_f32_16x16x32_bf16 v[72:75], v[144:147], v[168:171], v[72:75]
ds_read_b64_tr_b16 v[204:205], v238 offset:49152
v_mfma_f32_16x16x32_bf16 v[76:79], v[144:147], v[172:175], v[76:79]
ds_read_b64_tr_b16 v[206:207], v238 offset:51200
s_waitcnt lgkmcnt(15)
v_mfma_f32_16x16x32_bf16 v[92:95], v[148:151], v[172:175], v[92:95]
v_mfma_f32_16x16x32_bf16 v[88:91], v[148:151], v[168:171], v[88:91]
v_mfma_f32_16x16x32_bf16 v[84:87], v[148:151], v[164:167], v[84:87]
v_mfma_f32_16x16x32_bf16 v[80:83], v[148:151], v[160:163], v[80:83]
s_waitcnt lgkmcnt(15)
v_mfma_f32_16x16x32_bf16 v[96:99], v[152:155], v[160:163], v[96:99]
v_mfma_f32_16x16x32_bf16 v[100:103], v[152:155], v[164:167], v[100:103]
v_mfma_f32_16x16x32_bf16 v[104:107], v[152:155], v[168:171], v[104:107]
v_mfma_f32_16x16x32_bf16 v[108:111], v[152:155], v[172:175], v[108:111]
s_waitcnt lgkmcnt(15)
v_mfma_f32_16x16x32_bf16 v[124:127], v[156:159], v[172:175], v[124:127]
v_mfma_f32_16x16x32_bf16 v[120:123], v[156:159], v[168:171], v[120:123]
v_mfma_f32_16x16x32_bf16 v[116:119], v[156:159], v[164:167], v[116:119]
v_mfma_f32_16x16x32_bf16 v[112:115], v[156:159], v[160:163], v[112:115]
s_waitcnt lgkmcnt(0)
s_barrier
v_mfma_f32_16x16x32_bf16 v[0:3], v[176:179], v[208:211], v[0:3]
ds_read_b64_tr_b16 v[128:129], v225 offset:0
v_mfma_f32_16x16x32_bf16 v[4:7], v[176:179], v[212:215], v[4:7]
ds_read_b64_tr_b16 v[130:131], v225 offset:2048
v_mfma_f32_16x16x32_bf16 v[8:11], v[176:179], v[216:219], v[8:11]
ds_read_b128 v[160:163], v241 offset:0
v_mfma_f32_16x16x32_bf16 v[12:15], v[176:179], v[220:223], v[12:15]
ds_read_b128 v[164:167], v241 offset:2048
v_mfma_f32_16x16x32_bf16 v[28:31], v[180:183], v[220:223], v[28:31]
ds_read_b128 v[168:171], v241 offset:4096
v_mfma_f32_16x16x32_bf16 v[24:27], v[180:183], v[216:219], v[24:27]
ds_read_b128 v[172:175], v241 offset:6144
v_mfma_f32_16x16x32_bf16 v[20:23], v[180:183], v[212:215], v[20:23]
ds_read_b64_tr_b16 v[132:133], v227 offset:0
v_mfma_f32_16x16x32_bf16 v[16:19], v[180:183], v[208:211], v[16:19]
ds_read_b64_tr_b16 v[134:135], v227 offset:2048
v_mfma_f32_16x16x32_bf16 v[32:35], v[184:187], v[208:211], v[32:35]
ds_read_b64_tr_b16 v[136:137], v229 offset:0
v_mfma_f32_16x16x32_bf16 v[36:39], v[184:187], v[212:215], v[36:39]
ds_read_b64_tr_b16 v[138:139], v229 offset:2048
v_mfma_f32_16x16x32_bf16 v[40:43], v[184:187], v[216:219], v[40:43]
ds_read_b64_tr_b16 v[140:141], v231 offset:0
v_mfma_f32_16x16x32_bf16 v[44:47], v[184:187], v[220:223], v[44:47]
ds_read_b64_tr_b16 v[142:143], v231 offset:2048
v_mfma_f32_16x16x32_bf16 v[60:63], v[188:191], v[220:223], v[60:63]
ds_read_b64_tr_b16 v[144:145], v233 offset:0
v_mfma_f32_16x16x32_bf16 v[56:59], v[188:191], v[216:219], v[56:59]
ds_read_b64_tr_b16 v[146:147], v233 offset:2048
v_mfma_f32_16x16x32_bf16 v[52:55], v[188:191], v[212:215], v[52:55]
ds_read_b64_tr_b16 v[148:149], v235 offset:0
v_mfma_f32_16x16x32_bf16 v[48:51], v[188:191], v[208:211], v[48:51]
ds_read_b64_tr_b16 v[150:151], v235 offset:2048
v_mfma_f32_16x16x32_bf16 v[64:67], v[192:195], v[208:211], v[64:67]
ds_read_b64_tr_b16 v[152:153], v237 offset:0
v_mfma_f32_16x16x32_bf16 v[68:71], v[192:195], v[212:215], v[68:71]
ds_read_b64_tr_b16 v[154:155], v237 offset:2048
v_mfma_f32_16x16x32_bf16 v[72:75], v[192:195], v[216:219], v[72:75]
ds_read_b64_tr_b16 v[156:157], v239 offset:0
v_mfma_f32_16x16x32_bf16 v[76:79], v[192:195], v[220:223], v[76:79]
ds_read_b64_tr_b16 v[158:159], v239 offset:2048
v_mfma_f32_16x16x32_bf16 v[92:95], v[196:199], v[220:223], v[92:95]
v_mfma_f32_16x16x32_bf16 v[88:91], v[196:199], v[216:219], v[88:91]
v_mfma_f32_16x16x32_bf16 v[84:87], v[196:199], v[212:215], v[84:87]
v_mfma_f32_16x16x32_bf16 v[80:83], v[196:199], v[208:211], v[80:83]
v_mfma_f32_16x16x32_bf16 v[96:99], v[200:203], v[208:211], v[96:99]
v_mfma_f32_16x16x32_bf16 v[100:103], v[200:203], v[212:215], v[100:103]
v_mfma_f32_16x16x32_bf16 v[104:107], v[200:203], v[216:219], v[104:107]
v_mfma_f32_16x16x32_bf16 v[108:111], v[200:203], v[220:223], v[108:111]
v_mfma_f32_16x16x32_bf16 v[124:127], v[204:207], v[220:223], v[124:127]
v_mfma_f32_16x16x32_bf16 v[120:123], v[204:207], v[216:219], v[120:123]
v_mfma_f32_16x16x32_bf16 v[116:119], v[204:207], v[212:215], v[116:119]
v_mfma_f32_16x16x32_bf16 v[112:115], v[204:207], v[208:211], v[112:115]
px_c2:
s_waitcnt lgkmcnt(15)
v_mfma_f32_16x16x32_bf16 v[0:3], v[128:131], v[160:163], v[0:3]
ds_read_b64_tr_b16 v[176:177], v225 offset:16384
s_waitcnt lgkmcnt(15)
v_mfma_f32_16x16x32_bf16 v[4:7], v[128:131], v[164:167], v[4:7]
ds_read_b64_tr_b16 v[178:179], v225 offset:18432
s_waitcnt lgkmcnt(15)
v_mfma_f32_16x16x32_bf16 v[8:11], v[128:131], v[168:171], v[8:11]
ds_read_b128 v[208:211], v241 offset:1024
s_waitcnt lgkmcnt(15)
v_mfma_f32_16x16x32_bf16 v[12:15], v[128:131], v[172:175], v[12:15]
ds_read_b128 v[212:215], v241 offset:3072
s_waitcnt lgkmcnt(15)
v_mfma_f32_16x16x32_bf16 v[28:31], v[132:135], v[172:175], v[28:31]
ds_read_b128 v[216:219], v241 offset:5120
v_mfma_f32_16x16x32_bf16 v[24:27], v[132:135], v[168:171], v[24:27]
ds_read_b128 v[220:223], v241 offset:7168
v_mfma_f32_16x16x32_bf16 v[20:23], v[132:135], v[164:167], v[20:23]
ds_read_b64_tr_b16 v[180:181], v227 offset:16384
v_mfma_f32_16x16x32_bf16 v[16:19], v[132:135], v[160:163], v[16:19]
ds_read_b64_tr_b16 v[182:183], v227 offset:18432
s_waitcnt lgkmcnt(15)
v_mfma_f32_16x16x32_bf16 v[32:35], v[136:139], v[160:163], v[32:35]
ds_read_b64_tr_b16 v[184:185], v229 offset:16384
v_mfma_f32_16x16x32_bf16 v[36:39], v[136:139], v[164:167], v[36:39]
ds_read_b64_tr_b16 v[186:187], v229 offset:18432
v_mfma_f32_16x16x32_bf16 v[40:43], v[136:139], v[168:171], v[40:43]
ds_read_b64_tr_b16 v[188:189], v231 offset:16384
v_mfma_f32_16x16x32_bf16 v[44:47], v[136:139], v[172:175], v[44:47]
ds_read_b64_tr_b16 v[190:191], v231 offset:18432
s_waitcnt lgkmcnt(15)
v_mfma_f32_16x16x32_bf16 v[60:63], v[140:143], v[172:175], v[60:63]
ds_read_b64_tr_b16 v[192:193], v233 offset:16384
v_mfma_f32_16x16x32_bf16 v[56:59], v[140:143], v[168:171], v[56:59]
ds_read_b64_tr_b16 v[194:195], v233 offset:18432
v_mfma_f32_16x16x32_bf16 v[52:55], v[140:143], v[164:167], v[52:55]
ds_read_b64_tr_b16 v[196:197], v235 offset:16384
v_mfma_f32_16x16x32_bf16 v[48:51], v[140:143], v[160:163], v[48:51]
ds_read_b64_tr_b16 v[198:199], v235 offset:18432
s_waitcnt lgkmcnt(15)
v_mfma_f32_16x16x32_bf16 v[64:67], v[144:147], v[160:163], v[64:67]
ds_read_b64_tr_b16 v[200:201], v237 offset:16384
v_mfma_f32_16x16x32_bf16 v[68:71], v[144:147], v[164:167], v[68:71]
ds_read_b64_tr_b16 v[202:203], v237 offset:18432
v_mfma_f32_16x16x32_bf16 v[72:75], v[144:147], v[168:171], v[72:75]
ds_read_b64_tr_b16 v[204:205], v239 offset:16384
v_mfma_f32_16x16x32_bf16 v[76:79], v[144:147], v[172:175], v[76:79]
ds_read_b64_tr_b16 v[206:207], v239 offset:18432
s_waitcnt lgkmcnt(15)
v_mfma_f32_16x16x32_bf16 v[92:95], v[148:151], v[172:175], v[92:95]
v_mfma_f32_16x16x32_bf16 v[88:91], v[148:151], v[168:171], v[88:91]
v_mfma_f32_16x16x32_bf16 v[84:87], v[148:151], v[164:167], v[84:87]
v_mfma_f32_16x16x32_bf16 v[80:83], v[148:151], v[160:163], v[80:83]
s_waitcnt lgkmcnt(15)
v_mfma_f32_16x16x32_bf16 v[96:99], v[152:155], v[160:163], v[96:99]
v_mfma_f32_16x16x32_bf16 v[100:103], v[152:155], v[164:167], v[100:103]
v_mfma_f32_16x16x32_bf16 v[104:107], v[152:155], v[168:171], v[104:107]
v_mfma_f32_16x16x32_bf16 v[108:111], v[152:155], v[172:175], v[108:111]
s_waitcnt lgkmcnt(15)
v_mfma_f32_16x16x32_bf16 v[124:127], v[156:159], v[172:175], v[124:127]
v_mfma_f32_16x16x32_bf16 v[120:123], v[156:159], v[168:171], v[120:123]
v_mfma_f32_16x16x32_bf16 v[116:119], v[156:159], v[164:167], v[116:119]
v_mfma_f32_16x16x32_bf16 v[112:115], v[156:159], v[160:163], v[112:115]
s_waitcnt lgkmcnt(0)
s_barrier
v_mfma_f32_16x16x32_bf16 v[0:3], v[176:179], v[208:211], v[0:3]
ds_read_b64_tr_b16 v[128:129], v224 offset:0
v_mfma_f32_16x16x32_bf16 v[4:7], v[176:179], v[212:215], v[4:7]
ds_read_b64_tr_b16 v[130:131], v224 offset:2048
v_mfma_f32_16x16x32_bf16 v[8:11], v[176:179], v[216:219], v[8:11]
ds_read_b128 v[160:163], v240 offset:32768
v_mfma_f32_16x16x32_bf16 v[12:15], v[176:179], v[220:223], v[12:15]
ds_read_b128 v[164:167], v240 offset:34816
v_mfma_f32_16x16x32_bf16 v[28:31], v[180:183], v[220:223], v[28:31]
ds_read_b128 v[168:171], v240 offset:36864
v_mfma_f32_16x16x32_bf16 v[24:27], v[180:183], v[216:219], v[24:27]
ds_read_b128 v[172:175], v240 offset:38912
v_mfma_f32_16x16x32_bf16 v[20:23], v[180:183], v[212:215], v[20:23]
ds_read_b64_tr_b16 v[132:133], v226 offset:0
v_mfma_f32_16x16x32_bf16 v[16:19], v[180:183], v[208:211], v[16:19]
ds_read_b64_tr_b16 v[134:135], v226 offset:2048
v_mfma_f32_16x16x32_bf16 v[32:35], v[184:187], v[208:211], v[32:35]
ds_read_b64_tr_b16 v[136:137], v228 offset:0
v_mfma_f32_16x16x32_bf16 v[36:39], v[184:187], v[212:215], v[36:39]
ds_read_b64_tr_b16 v[138:139], v228 offset:2048
v_mfma_f32_16x16x32_bf16 v[40:43], v[184:187], v[216:219], v[40:43]
ds_read_b64_tr_b16 v[140:141], v230 offset:0
v_mfma_f32_16x16x32_bf16 v[44:47], v[184:187], v[220:223], v[44:47]
ds_read_b64_tr_b16 v[142:143], v230 offset:2048
v_mfma_f32_16x16x32_bf16 v[60:63], v[188:191], v[220:223], v[60:63]
ds_read_b64_tr_b16 v[144:145], v232 offset:0
v_mfma_f32_16x16x32_bf16 v[56:59], v[188:191], v[216:219], v[56:59]
ds_read_b64_tr_b16 v[146:147], v232 offset:2048
v_mfma_f32_16x16x32_bf16 v[52:55], v[188:191], v[212:215], v[52:55]
ds_read_b64_tr_b16 v[148:149], v234 offset:0
v_mfma_f32_16x16x32_bf16 v[48:51], v[188:191], v[208:211], v[48:51]
ds_read_b64_tr_b16 v[150:151], v234 offset:2048
v_mfma_f32_16x16x32_bf16 v[64:67], v[192:195], v[208:211], v[64:67]
ds_read_b64_tr_b16 v[152:153], v236 offset:0
v_mfma_f32_16x16x32_bf16 v[68:71], v[192:195], v[212:215], v[68:71]
ds_read_b64_tr_b16 v[154:155], v236 offset:2048
v_mfma_f32_16x16x32_bf16 v[72:75], v[192:195], v[216:219], v[72:75]
ds_read_b64_tr_b16 v[156:157], v238 offset:0
v_mfma_f32_16x16x32_bf16 v[76:79], v[192:195], v[220:223], v[76:79]
ds_read_b64_tr_b16 v[158:159], v238 offset:2048
v_mfma_f32_16x16x32_bf16 v[92:95], v[196:199], v[220:223], v[92:95]
v_mfma_f32_16x16x32_bf16 v[88:91], v[196:199], v[216:219], v[88:91]
v_mfma_f32_16x16x32_bf16 v[84:87], v[196:199], v[212:215], v[84:87]
v_mfma_f32_16x16x32_bf16 v[80:83], v[196:199], v[208:211], v[80:83]
v_mfma_f32_16x16x32_bf16 v[96:99], v[200:203], v[208:211], v[96:99]
v_mfma_f32_16x16x32_bf16 v[100:103], v[200:203], v[212:215], v[100:103]
v_mfma_f32_16x16x32_bf16 v[104:107], v[200:203], v[216:219], v[104:107]
v_mfma_f32_16x16x32_bf16 v[108:111], v[200:203], v[220:223], v[108:111]
v_mfma_f32_16x16x32_bf16 v[124:127], v[204:207], v[220:223], v[124:127]
v_mfma_f32_16x16x32_bf16 v[120:123], v[204:207], v[216:219], v[120:123]
v_mfma_f32_16x16x32_bf16 v[116:119], v[204:207], v[212:215], v[116:119]
s_sub_u32 s19, s19, 1
s_cmp_lg_u32 s19, 0
v_mfma_f32_16x16x32_bf16 v[112:115], v[204:207], v[208:211], v[112:115]
s_cbranch_scc1 px_c0
s_waitcnt lgkmcnt(0)
s_barrier
s_nop 7
v_lshlrev_b32 v208, 4, v250
s_lshl_b32 s36, s42, 4
s_lshl_b32 s37, s44, 2
s_add_u32 s36, s36, s37
s_lshl_b32 s37, s17, 1
s_add_u32 s36, s36, s37
s_lshl_b32 s36, s36, 15
s_lshl_b32 s37, s18, 13
s_add_u32 s36, s36, s37
s_and_b32 s37, s45, 1
s_lshl_b32 s37, s37, 14
s_add_u32 s36, s36, s37
s_add_u32 s37, s36, 0
v_cvt_pk_bf16_f32 v128, v0, v1
v_cvt_pk_bf16_f32 v129, v2, v3
v_cvt_pk_bf16_f32 v130, v16, v17
v_cvt_pk_bf16_f32 v131, v18, v19
buffer_store_dwordx4 v[128:131], v208, s[12:15], s37 offen offset:0 sc1
v_cvt_pk_bf16_f32 v132, v32, v33
v_cvt_pk_bf16_f32 v133, v34, v35
v_cvt_pk_bf16_f32 v134, v48, v49
v_cvt_pk_bf16_f32 v135, v50, v51
buffer_store_dwordx4 v[132:135], v208, s[12:15], s37 offen offset:1024 sc1
s_add_u32 s37, s36, 2048
v_cvt_pk_bf16_f32 v136, v4, v5
v_cvt_pk_bf16_f32 v137, v6, v7
v_cvt_pk_bf16_f32 v138, v20, v21
v_cvt_pk_bf16_f32 v139, v22, v23
buffer_store_dwordx4 v[136:139], v208, s[12:15], s37 offen offset:0 sc1
v_cvt_pk_bf16_f32 v140, v36, v37
v_cvt_pk_bf16_f32 v141, v38, v39
v_cvt_pk_bf16_f32 v142, v52, v53
v_cvt_pk_bf16_f32 v143, v54, v55
buffer_store_dwordx4 v[140:143], v208, s[12:15], s37 offen offset:1024 sc1
s_add_u32 s37, s36, 4096
v_cvt_pk_bf16_f32 v144, v8, v9
v_cvt_pk_bf16_f32 v145, v10, v11
v_cvt_pk_bf16_f32 v146, v24, v25
v_cvt_pk_bf16_f32 v147, v26, v27
buffer_store_dwordx4 v[144:147], v208, s[12:15], s37 offen offset:0 sc1
v_cvt_pk_bf16_f32 v148, v40, v41
v_cvt_pk_bf16_f32 v149, v42, v43
v_cvt_pk_bf16_f32 v150, v56, v57
v_cvt_pk_bf16_f32 v151, v58, v59
buffer_store_dwordx4 v[148:151], v208, s[12:15], s37 offen offset:1024 sc1
s_add_u32 s37, s36, 6144
v_cvt_pk_bf16_f32 v152, v12, v13
v_cvt_pk_bf16_f32 v153, v14, v15
v_cvt_pk_bf16_f32 v154, v28, v29
v_cvt_pk_bf16_f32 v155, v30, v31
buffer_store_dwordx4 v[152:155], v208, s[12:15], s37 offen offset:0 sc1
v_cvt_pk_bf16_f32 v156, v44, v45
v_cvt_pk_bf16_f32 v157, v46, v47
v_cvt_pk_bf16_f32 v158, v60, v61
v_cvt_pk_bf16_f32 v159, v62, v63
buffer_store_dwordx4 v[156:159], v208, s[12:15], s37 offen offset:1024 sc1
s_add_u32 s37, s36, 32768
v_cvt_pk_bf16_f32 v160, v64, v65
v_cvt_pk_bf16_f32 v161, v66, v67
v_cvt_pk_bf16_f32 v162, v80, v81
v_cvt_pk_bf16_f32 v163, v82, v83
buffer_store_dwordx4 v[160:163], v208, s[12:15], s37 offen offset:0 sc1
v_cvt_pk_bf16_f32 v164, v96, v97
v_cvt_pk_bf16_f32 v165, v98, v99
v_cvt_pk_bf16_f32 v166, v112, v113
v_cvt_pk_bf16_f32 v167, v114, v115
buffer_store_dwordx4 v[164:167], v208, s[12:15], s37 offen offset:1024 sc1
s_add_u32 s37, s36, 34816
v_cvt_pk_bf16_f32 v168, v68, v69
v_cvt_pk_bf16_f32 v169, v70, v71
v_cvt_pk_bf16_f32 v170, v84, v85
v_cvt_pk_bf16_f32 v171, v86, v87
buffer_store_dwordx4 v[168:171], v208, s[12:15], s37 offen offset:0 sc1
v_cvt_pk_bf16_f32 v172, v100, v101
v_cvt_pk_bf16_f32 v173, v102, v103
v_cvt_pk_bf16_f32 v174, v116, v117
v_cvt_pk_bf16_f32 v175, v118, v119
buffer_store_dwordx4 v[172:175], v208, s[12:15], s37 offen offset:1024 sc1
s_add_u32 s37, s36, 36864
v_cvt_pk_bf16_f32 v176, v72, v73
v_cvt_pk_bf16_f32 v177, v74, v75
v_cvt_pk_bf16_f32 v178, v88, v89
v_cvt_pk_bf16_f32 v179, v90, v91
buffer_store_dwordx4 v[176:179], v208, s[12:15], s37 offen offset:0 sc1
v_cvt_pk_bf16_f32 v180, v104, v105
v_cvt_pk_bf16_f32 v181, v106, v107
v_cvt_pk_bf16_f32 v182, v120, v121
v_cvt_pk_bf16_f32 v183, v122, v123
buffer_store_dwordx4 v[180:183], v208, s[12:15], s37 offen offset:1024 sc1
s_add_u32 s37, s36, 38912
v_cvt_pk_bf16_f32 v184, v76, v77
v_cvt_pk_bf16_f32 v185, v78, v79
v_cvt_pk_bf16_f32 v186, v92, v93
v_cvt_pk_bf16_f32 v187, v94, v95
buffer_store_dwordx4 v[184:187], v208, s[12:15], s37 offen offset:0 sc1
v_cvt_pk_bf16_f32 v188, v108, v109
v_cvt_pk_bf16_f32 v189, v110, v111
v_cvt_pk_bf16_f32 v190, v124, v125
v_cvt_pk_bf16_f32 v191, v126, v127
buffer_store_dwordx4 v[188:191], v208, s[12:15], s37 offen offset:1024 sc1
v_mov_b32 v210, 0
s_mov_b32 s19, 32768
nn_28:
buffer_load_dwordx2 v[212:213], v210, s[28:31], 0 offen sc1
s_waitcnt vmcnt(0)
v_readfirstlane_b32 s66, v212
v_readfirstlane_b32 s67, v213
s_nop 3
s_cmp_lg_u32 s66, 0
s_cbranch_scc1 nd_29
s_sleep 4
s_sub_u32 s19, s19, 1
s_cmp_lg_u32 s19, 0
s_cbranch_scc1 nn_28
nd_29:
s_lshl_b32 s40, s42, 8
s_lshr_b32 s41, s44, 1
s_lshl_b32 s41, s41, 7
s_add_u32 s40, s40, s41
s_and_b32 s41, s45, 1
s_lshl_b32 s41, s41, 6
s_add_u32 s40, s40, s41
s_and_b32 s41, s44, 1
s_lshl_b32 s41, s41, 5
s_add_u32 s40, s40, s41
s_and_b32 s41, s16, 3
s_lshl_b32 s41, s41, 3
s_add_u32 s40, s40, s41
s_add_u32 s40, s40, 8192
s_waitcnt vmcnt(0)
v_mov_b32 v214, 0
v_mov_b32 v216, s66
v_mov_b32 v217, s67
s_mov_b64 exec, 1
buffer_store_dwordx2 v[216:217], v214, s[24:27], s40 offen sc1
s_mov_b64 exec, -1
s_and_b32 s36, s16, 3
s_getpc_b64 s[38:39]
cp_30:
s_sub_u32 s38, s38, cp_30-standalone__weight_only_int_quip__prompt_kernel
s_subb_u32 s39, s39, 0
s_lshl_b32 s19, s36, 13
v_mbcnt_lo_u32_b32 v218, -1, 0
v_mbcnt_hi_u32_b32 v218, -1, v218
v_lshl_add_u32 v218, v218, 7, s19
v_min_u32 v218, L_end-standalone__weight_only_int_quip__prompt_kernel, v218
global_load_dword v251, v218, s[38:39]
s_add_u32 s46, s46, 1
s_cmp_lt_u32 s46, 2
s_cbranch_scc1 L_xc2
L_end:
s_endpgm
.section .rodata,"a"
.p2align 6
.amdhsa_kernel standalone__weight_only_int_quip__prompt_kernel
  .amdhsa_next_free_vgpr 252
  .amdhsa_next_free_sgpr 102
  .amdhsa_accum_offset 252
  .amdhsa_group_segment_fixed_size 0
  .amdhsa_kernarg_size 72
  .amdhsa_user_sgpr_count 2
  .amdhsa_user_sgpr_kernarg_segment_ptr 1
  .amdhsa_system_sgpr_workgroup_id_x 1
  .amdhsa_float_denorm_mode_32 3
.end_amdhsa_kernel
```
